```python
import torch

def _softmax(x, axis=-1):
    return torch.softmax(x, dim=axis)
def _gelu(x):
    return torch.nn.functional.gelu(x, approximate="tanh")
def _silu(x):
    return torch.nn.functional.silu(x)
def _sigmoid(x):
    return torch.sigmoid(x)
def _layernorm(x, axis=-1, eps=1e-5):
    m = x.mean(dim=axis, keepdim=True)
    v = x.var(dim=axis, keepdim=True, unbiased=False)
    return (x - m) / torch.sqrt(v + eps)
def _scatter_add(tgt, idx, src, axis=0):
    return tgt.clone().index_add_(axis, idx, src)
def _segment_sum(src, seg, n):
    out = torch.zeros((n,) + src.shape[1:], dtype=src.dtype)
    return out.index_add_(0, seg, src)
def _pad(x, pw):
    flat = tuple(v for pair in reversed(pw) for v in pair)
    return torch.nn.functional.pad(x, flat)

kernel_name = 'sequential_preLN__mha_block__dense_activation_silu__prompt'

def setup_inputs():

    _w = (lambda a: (lambda t: t.to(torch.bfloat16) if t.is_floating_point() else t)(torch.as_tensor(a)))
    def _A_setup():
        B, S, D, H = 1, 2048, 512, 32
        return {
            "x": _w((lambda *s: torch.randn(*s, dtype=torch.bfloat16) * 0.05)(B, S, D)),
            "wqkv": _w((lambda *s: torch.randn(*s, dtype=torch.bfloat16) * 0.05)(D, 3 * D)),
            "wo": _w((lambda *s: torch.randn(*s, dtype=torch.bfloat16) * 0.05)(D, D)),
        }
    _A_in = _A_setup()

    def _B_setup():
        B, S, D, F = 1, 2048, 512, 1376
        return {
            "x": _w((lambda *s: torch.randn(*s, dtype=torch.bfloat16) * 0.05)(B, S, D)),
            "w1": _w((lambda *s: torch.randn(*s, dtype=torch.bfloat16) * 0.8)(D, F) * (D ** -0.5)),
            "w2": _w((lambda *s: torch.randn(*s, dtype=torch.bfloat16) * 0.2)(F, D) * (F ** -0.5)),
        }
    _B_in = _B_setup()

    return {
        "A_x": _A_in["x"],
        "A_wqkv": _A_in["wqkv"],
        "A_wo": _A_in["wo"],
        "B_x": _B_in["x"],
        "B_w1": _B_in["w1"],
        "B_w2": _B_in["w2"],
    }

def reference(A_x, A_wqkv, A_wo, B_x, B_w1, B_w2):
    def _A_ref(x, wqkv, wo):
        B, S, D = x.shape
        H = 32
        Dh = D // H
        qkv = (lambda x, *d: x.permute(*d))((x @ wqkv).reshape(B, S, 3, H, Dh), 2, 0, 3, 1, 4)
        q, k, v = qkv[0], qkv[1], qkv[2]
        scores = torch.einsum("bhqd,bhkd->bhqk", q, k) * (Dh ** -0.5)
        p = _softmax(scores, axis=-1)
        o = torch.einsum("bhqk,bhkd->bhqd", p, v)
        return (lambda x, *d: x.permute(*d))(o, 0, 2, 1, 3).reshape(B, S, D) @ wo

    def _B_ref(x, w1, w2):
        h = torch.einsum("bsd,df->bsf", x, w1)
        h = _silu(h)
        out = torch.einsum("bsf,fd->bsd", h, w2)
        return out

    x = A_x
    h = x + _A_ref(_layernorm(x, axis=-1), A_wqkv, A_wo)
    h2 = h + _B_ref(_layernorm(h, axis=-1), B_w1, B_w2)
    return h2
```

```asm
; @launch grid=(256,1,1) block=(512,1,1) lds=163840
.amdgcn_target "amdgcn-amd-amdhsa--gfx950"
.text
.globl sequential_preLN__mha_block__dense_activation_silu__prompt_kernel
.p2align 8
.type sequential_preLN__mha_block__dense_activation_silu__prompt_kernel,@function
sequential_preLN__mha_block__dense_activation_silu__prompt_kernel:
    s_cmp_ge_u32 s2, 256
    s_cbranch_scc1 .Lend
    s_load_dwordx2 s[8:9], s[0:1], 0
    s_mov_b32 s10, 2097152
    s_mov_b32 s11, 0x00020000
    s_load_dwordx2 s[12:13], s[0:1], 8
    s_mov_b32 s14, 1572864
    s_mov_b32 s15, 0x00020000
    s_load_dwordx2 s[4:5], s[0:1], 64
    s_mov_b32 s6, 16777216
    s_mov_b32 s7, 0x00020000
    s_load_dwordx2 s[16:17], s[0:1], 16
    s_mov_b32 s18, 524288
    s_mov_b32 s19, 0x00020000
    s_load_dwordx2 s[24:25], s[0:1], 32
    s_mov_b32 s26, 1409024
    s_mov_b32 s27, 0x00020000
    s_load_dwordx2 s[28:29], s[0:1], 40
    s_mov_b32 s30, 1409024
    s_mov_b32 s31, 0x00020000
    s_load_dwordx2 s[32:33], s[0:1], 48
    s_mov_b32 s34, 2097152
    s_mov_b32 s35, 0x00020000
    s_load_dwordx2 s[20:21], s[0:1], 56
    s_mov_b32 s22, 256
    s_mov_b32 s23, 0x00020000
    v_lshrrev_b32 v2, 6, v0
    v_and_b32 v1, 63, v0
    v_readfirstlane_b32 s40, v2
    s_and_b32 s46, s2, 7
    s_lshr_b32 s47, s2, 3
    s_getreg_b32 s42, hwreg(HW_REG_XCC_ID, 0, 3)
    s_lshl_b32 s43, s46, 1
    s_lshr_b32 s48, s47, 4
    s_add_u32 s43, s43, s48
    s_and_b32 s44, s47, 15
    s_mov_b32 s45, 0x8000
    s_cmp_lg_u32 s40, 1
    s_cbranch_scc1 .La_noct
    s_getpc_b64 s[46:47]
.Lpc:
    s_lshr_b32 s48, s2, 3
    s_mul_i32 s48, s48, 1152
    v_min_u32 v3, 8, v1
    v_lshlrev_b32 v3, 7, v3
    v_add_u32 v3, s48, v3
    v_min_u32 v3, .Lcode_end-.Lpc-4, v3
    v_mov_b32 v5, s47
    v_add_co_u32 v4, vcc, s46, v3
    s_nop 1
    v_addc_co_u32 v5, vcc, 0, v5, vcc
    global_load_dword v0, v[4:5], off
.La_noct:
    s_cmp_ge_u32 s40, 4
    s_cbranch_scc0 .La_mfma
    s_sub_u32 s36, s40, 4
    v_lshrrev_b32 v2, 3, v1
    v_lshlrev_b32 v2, 10, v2
    v_lshrrev_b32 v3, 4, v1
    v_and_b32 v4, 7, v1
    v_xor_b32 v3, v3, v4
    v_lshl_add_u32 v2, v3, 4, v2
    v_xor_b32 v3, 64, v2
    v_add_u32 v4, 14336, v2
    v_add_u32 v5, 21504, v3
    v_add_u32 v3, 7168, v3
    v_lshrrev_b32 v8, 2, v1
    v_mul_u32_u24 v8, 3072, v8
    v_and_b32 v7, 3, v1
    v_lshl_add_u32 v8, v7, 4, v8
    s_lshl_b32 s48, s43, 2
    s_add_u32 s48, s48, s36
    s_lshl_b32 s48, s48, 15
    s_mul_i32 s49, s36, 49152
    s_lshl_b32 s47, s44, 6
    s_add_u32 s49, s49, s47
    s_mul_i32 s50, s36, 12288
    s_add_u32 s50, s50, 16384
    s_lshl_b32 s51, s36, 11
    s_add_u32 s51, s51, 64512
    s_lshr_b32 s54, s44, 1
    s_add_u32 s54, s54, 4
    s_mul_i32 s55, s2, 1
    s_add_u32 s54, s54, s55
    s_and_b32 s54, s54, 7
    s_mov_b32 s57, s54
    s_waitcnt lgkmcnt(0)
    s_lshl_b32 s55, s54, 7
    s_add_u32 s55, s55, s48
    s_add_u32 m0, s50, 0
    s_add_u32 s54, s54, 1
    buffer_load_dwordx4 v2, s[8:11], s55 offen lds
    buffer_load_dwordx4 v3, s[8:11], s55 offen offset:1024 lds
    buffer_load_dwordx4 v4, s[8:11], s55 offen offset:2048 lds
    buffer_load_dwordx4 v5, s[8:11], s55 offen offset:3072 lds
    s_and_b32 s54, s54, 7
    s_mul_i32 s56, s57, 196608
    s_add_u32 s56, s56, s49
    s_add_u32 m0, s51, 0
    s_add_u32 s57, s57, 1
    buffer_load_dwordx4 v8, s[12:15], s56 offen offset:1024 lds
    buffer_load_dwordx4 v8, s[12:15], s56 offen offset:2048 lds
    s_and_b32 s57, s57, 7
    s_mul_i32 s56, s57, 196608
    s_add_u32 s56, s56, s49
    s_add_u32 m0, s51, 8192
    s_add_u32 s57, s57, 1
    buffer_load_dwordx4 v8, s[12:15], s56 offen offset:1024 lds
    buffer_load_dwordx4 v8, s[12:15], s56 offen offset:2048 lds
    s_and_b32 s57, s57, 7
    s_lshl_b32 s55, s54, 7
    s_add_u32 s55, s55, s48
    s_add_u32 m0, s50, 4096
    s_add_u32 s54, s54, 1
    buffer_load_dwordx4 v2, s[8:11], s55 offen lds
    buffer_load_dwordx4 v3, s[8:11], s55 offen offset:1024 lds
    buffer_load_dwordx4 v4, s[8:11], s55 offen offset:2048 lds
    buffer_load_dwordx4 v5, s[8:11], s55 offen offset:3072 lds
    s_and_b32 s54, s54, 7
    s_mul_i32 s56, s57, 196608
    s_add_u32 s56, s56, s49
    s_add_u32 m0, s51, 16384
    s_add_u32 s57, s57, 1
    buffer_load_dwordx4 v8, s[12:15], s56 offen offset:1024 lds
    buffer_load_dwordx4 v8, s[12:15], s56 offen offset:2048 lds
    s_and_b32 s57, s57, 7
    s_lshl_b32 s52, s36, 10
    s_add_u32 s52, s52, 122880
    v_and_b32 v9, 31, v1
    v_lshlrev_b32 v9, 2, v9
    v_mov_b32 v7, 0x3f803f80
    s_mov_b32 s46, 0x10100101
    s_mov_b32 s47, 0x10100101
    v_cndmask_b32 v36, 0, v7, s[46:47]
    v_cndmask_b32 v37, 0, v7, s[46:47]
    v_cndmask_b32 v38, 0, v7, s[46:47]
    v_cndmask_b32 v39, 0, v7, s[46:47]
    v_bfe_u32 v10, v1, 2, 2
    v_lshrrev_b32 v7, 5, v1
    v_lshl_add_u32 v10, v7, 3, v10
    v_lshlrev_b32 v10, 6, v10
    v_bfe_u32 v7, v1, 4, 1
    v_lshl_add_u32 v10, v7, 5, v10
    v_and_b32 v7, 3, v1
    v_lshl_add_u32 v10, v7, 3, v10
    v_add_u32 v11, s52, v10
    s_add_u32 s46, s51, 1024
    v_add_u32 v10, s46, v10
    s_lshl_b32 s46, s36, 2
    s_add_u32 s46, s46, 159744
    v_lshl_add_u32 v12, v9, 2, s46
    s_lshl_b32 s46, s36, 2
    s_add_u32 s46, s46, 161792
    v_mov_b32 v13, s46
    v_mov_b32 v14, 0
    ds_write_b32 v13, v14
    s_waitcnt vmcnt(8)
    s_barrier
    s_lshl_b32 s55, s54, 7
    s_add_u32 s55, s55, s48
    s_add_u32 m0, s50, 8192
    s_add_u32 s54, s54, 1
    buffer_load_dwordx4 v2, s[8:11], s55 offen lds
    buffer_load_dwordx4 v3, s[8:11], s55 offen offset:1024 lds
    buffer_load_dwordx4 v4, s[8:11], s55 offen offset:2048 lds
    buffer_load_dwordx4 v5, s[8:11], s55 offen offset:3072 lds
    s_and_b32 s54, s54, 7
    s_mul_i32 s56, s57, 196608
    s_add_u32 s56, s56, s49
    s_add_u32 m0, s51, 24576
    s_add_u32 s57, s57, 1
    buffer_load_dwordx4 v8, s[12:15], s56 offen offset:1024 lds
    buffer_load_dwordx4 v8, s[12:15], s56 offen offset:2048 lds
    s_and_b32 s57, s57, 7
    ds_read_b64_tr_b16 v[16:17], v10 offset:0
    ds_read_b64_tr_b16 v[18:19], v10 offset:256
    ds_read_b64_tr_b16 v[20:21], v10 offset:1024
    ds_read_b64_tr_b16 v[22:23], v10 offset:1280
    s_waitcnt lgkmcnt(2)
    v_mfma_f32_16x16x32_bf16 v[24:27], v[36:39], v[16:19], 0
    s_waitcnt lgkmcnt(0)
    v_mfma_f32_16x16x32_bf16 v[28:31], v[36:39], v[20:23], 0
    s_nop 1
    s_waitcnt vmcnt(12)
    ds_read_b64_tr_b16 v[16:17], v10 offset:8192
    ds_read_b64_tr_b16 v[18:19], v10 offset:8448
    ds_read_b64_tr_b16 v[20:21], v10 offset:9216
    ds_read_b64_tr_b16 v[22:23], v10 offset:9472
    s_waitcnt lgkmcnt(2)
    v_mfma_f32_16x16x32_bf16 v[24:27], v[36:39], v[16:19], v[24:27]
    s_waitcnt lgkmcnt(0)
    v_mfma_f32_16x16x32_bf16 v[28:31], v[36:39], v[20:23], v[28:31]
    s_waitcnt vmcnt(8)
    s_barrier
    s_lshl_b32 s55, s54, 7
    s_add_u32 s55, s55, s48
    s_add_u32 m0, s50, 0
    s_add_u32 s54, s54, 1
    buffer_load_dwordx4 v2, s[8:11], s55 offen lds
    buffer_load_dwordx4 v3, s[8:11], s55 offen offset:1024 lds
    buffer_load_dwordx4 v4, s[8:11], s55 offen offset:2048 lds
    buffer_load_dwordx4 v5, s[8:11], s55 offen offset:3072 lds
    s_and_b32 s54, s54, 7
    s_mul_i32 s56, s57, 196608
    s_add_u32 s56, s56, s49
    s_add_u32 m0, s51, 0
    s_add_u32 s57, s57, 1
    buffer_load_dwordx4 v8, s[12:15], s56 offen offset:1024 lds
    buffer_load_dwordx4 v8, s[12:15], s56 offen offset:2048 lds
    s_and_b32 s57, s57, 7
    s_waitcnt vmcnt(12)
    ds_read_b64_tr_b16 v[16:17], v10 offset:16384
    ds_read_b64_tr_b16 v[18:19], v10 offset:16640
    ds_read_b64_tr_b16 v[20:21], v10 offset:17408
    ds_read_b64_tr_b16 v[22:23], v10 offset:17664
    s_waitcnt lgkmcnt(2)
    v_mfma_f32_16x16x32_bf16 v[24:27], v[36:39], v[16:19], v[24:27]
    s_waitcnt lgkmcnt(0)
    v_mfma_f32_16x16x32_bf16 v[28:31], v[36:39], v[20:23], v[28:31]
    s_waitcnt vmcnt(8)
    s_barrier
    s_lshl_b32 s55, s54, 7
    s_add_u32 s55, s55, s48
    s_add_u32 m0, s50, 4096
    s_add_u32 s54, s54, 1
    buffer_load_dwordx4 v2, s[8:11], s55 offen lds
    buffer_load_dwordx4 v3, s[8:11], s55 offen offset:1024 lds
    buffer_load_dwordx4 v4, s[8:11], s55 offen offset:2048 lds
    buffer_load_dwordx4 v5, s[8:11], s55 offen offset:3072 lds
    s_and_b32 s54, s54, 7
    s_mul_i32 s56, s57, 196608
    s_add_u32 s56, s56, s49
    s_add_u32 m0, s51, 8192
    s_add_u32 s57, s57, 1
    buffer_load_dwordx4 v8, s[12:15], s56 offen offset:1024 lds
    buffer_load_dwordx4 v8, s[12:15], s56 offen offset:2048 lds
    s_and_b32 s57, s57, 7
    s_waitcnt vmcnt(12)
    ds_read_b64_tr_b16 v[16:17], v10 offset:24576
    ds_read_b64_tr_b16 v[18:19], v10 offset:24832
    ds_read_b64_tr_b16 v[20:21], v10 offset:25600
    ds_read_b64_tr_b16 v[22:23], v10 offset:25856
    s_waitcnt lgkmcnt(2)
    v_mfma_f32_16x16x32_bf16 v[24:27], v[36:39], v[16:19], v[24:27]
    s_waitcnt lgkmcnt(0)
    v_mfma_f32_16x16x32_bf16 v[28:31], v[36:39], v[20:23], v[28:31]
    s_waitcnt vmcnt(8)
    s_barrier
    s_lshl_b32 s55, s54, 7
    s_add_u32 s55, s55, s48
    s_add_u32 m0, s50, 8192
    s_add_u32 s54, s54, 1
    buffer_load_dwordx4 v2, s[8:11], s55 offen lds
    buffer_load_dwordx4 v3, s[8:11], s55 offen offset:1024 lds
    buffer_load_dwordx4 v4, s[8:11], s55 offen offset:2048 lds
    buffer_load_dwordx4 v5, s[8:11], s55 offen offset:3072 lds
    s_and_b32 s54, s54, 7
    s_mul_i32 s56, s57, 196608
    s_add_u32 s56, s56, s49
    s_add_u32 m0, s51, 16384
    s_add_u32 s57, s57, 1
    buffer_load_dwordx4 v8, s[12:15], s56 offen offset:1024 lds
    buffer_load_dwordx4 v8, s[12:15], s56 offen offset:2048 lds
    s_and_b32 s57, s57, 7
    s_waitcnt vmcnt(12)
    ds_read_b64_tr_b16 v[16:17], v10 offset:0
    ds_read_b64_tr_b16 v[18:19], v10 offset:256
    ds_read_b64_tr_b16 v[20:21], v10 offset:1024
    ds_read_b64_tr_b16 v[22:23], v10 offset:1280
    s_waitcnt lgkmcnt(2)
    v_mfma_f32_16x16x32_bf16 v[24:27], v[36:39], v[16:19], v[24:27]
    s_waitcnt lgkmcnt(0)
    v_mfma_f32_16x16x32_bf16 v[28:31], v[36:39], v[20:23], v[28:31]
    s_waitcnt vmcnt(8)
    s_barrier
    s_lshl_b32 s55, s54, 7
    s_add_u32 s55, s55, s48
    s_add_u32 m0, s50, 0
    s_add_u32 s54, s54, 1
    buffer_load_dwordx4 v2, s[8:11], s55 offen lds
    buffer_load_dwordx4 v3, s[8:11], s55 offen offset:1024 lds
    buffer_load_dwordx4 v4, s[8:11], s55 offen offset:2048 lds
    buffer_load_dwordx4 v5, s[8:11], s55 offen offset:3072 lds
    s_and_b32 s54, s54, 7
    s_mul_i32 s56, s57, 196608
    s_add_u32 s56, s56, s49
    s_add_u32 m0, s51, 24576
    s_add_u32 s57, s57, 1
    buffer_load_dwordx4 v8, s[12:15], s56 offen offset:1024 lds
    buffer_load_dwordx4 v8, s[12:15], s56 offen offset:2048 lds
    s_and_b32 s57, s57, 7
    s_waitcnt vmcnt(12)
    ds_read_b64_tr_b16 v[16:17], v10 offset:8192
    ds_read_b64_tr_b16 v[18:19], v10 offset:8448
    ds_read_b64_tr_b16 v[20:21], v10 offset:9216
    ds_read_b64_tr_b16 v[22:23], v10 offset:9472
    s_waitcnt lgkmcnt(2)
    v_mfma_f32_16x16x32_bf16 v[24:27], v[36:39], v[16:19], v[24:27]
    s_waitcnt lgkmcnt(0)
    v_mfma_f32_16x16x32_bf16 v[28:31], v[36:39], v[20:23], v[28:31]
    s_waitcnt vmcnt(8)
    s_barrier
    s_lshl_b32 s55, s54, 7
    s_add_u32 s55, s55, s48
    s_add_u32 m0, s50, 4096
    s_add_u32 s54, s54, 1
    buffer_load_dwordx4 v2, s[8:11], s55 offen lds
    buffer_load_dwordx4 v3, s[8:11], s55 offen offset:1024 lds
    buffer_load_dwordx4 v4, s[8:11], s55 offen offset:2048 lds
    buffer_load_dwordx4 v5, s[8:11], s55 offen offset:3072 lds
    s_and_b32 s54, s54, 7
    s_waitcnt vmcnt(10)
    ds_read_b64_tr_b16 v[16:17], v10 offset:16384
    ds_read_b64_tr_b16 v[18:19], v10 offset:16640
    ds_read_b64_tr_b16 v[20:21], v10 offset:17408
    ds_read_b64_tr_b16 v[22:23], v10 offset:17664
    s_waitcnt lgkmcnt(2)
    v_mfma_f32_16x16x32_bf16 v[24:27], v[36:39], v[16:19], v[24:27]
    s_waitcnt lgkmcnt(0)
    v_mfma_f32_16x16x32_bf16 v[28:31], v[36:39], v[20:23], v[28:31]
    s_waitcnt vmcnt(6)
    s_barrier
    buffer_load_dword v15, v9, s[20:23], 0 offen sc1
    s_waitcnt vmcnt(5)
    ds_read_b64_tr_b16 v[16:17], v10 offset:24576
    ds_read_b64_tr_b16 v[18:19], v10 offset:24832
    ds_read_b64_tr_b16 v[20:21], v10 offset:25600
    ds_read_b64_tr_b16 v[22:23], v10 offset:25856
    s_waitcnt lgkmcnt(2)
    v_mfma_f32_16x16x32_bf16 v[24:27], v[36:39], v[16:19], v[24:27]
    s_waitcnt lgkmcnt(0)
    v_mfma_f32_16x16x32_bf16 v[28:31], v[36:39], v[20:23], v[28:31]
    s_nop 7
    ds_write_b32 v12, v24 offset:0
    ds_write_b32 v12, v28 offset:512
    s_waitcnt lgkmcnt(0)
    s_waitcnt vmcnt(1)
    s_barrier
    s_mul_i32 s56, s57, 196608
    s_add_u32 s56, s56, s49
    s_add_u32 m0, s52, 0
    s_add_u32 s57, s57, 1
    buffer_load_dwordx4 v8, s[12:15], s56 offen lds
    s_and_b32 s57, s57, 7
    s_mul_i32 s56, s57, 196608
    s_add_u32 s56, s56, s49
    s_add_u32 m0, s52, 4096
    s_add_u32 s57, s57, 1
    buffer_load_dwordx4 v8, s[12:15], s56 offen lds
    s_and_b32 s57, s57, 7
    s_mul_i32 s56, s57, 196608
    s_add_u32 s56, s56, s49
    s_add_u32 m0, s52, 8192
    s_add_u32 s57, s57, 1
    buffer_load_dwordx4 v8, s[12:15], s56 offen lds
    s_and_b32 s57, s57, 7
    s_mul_i32 s56, s57, 196608
    s_add_u32 s56, s56, s49
    s_add_u32 m0, s52, 12288
    s_add_u32 s57, s57, 1
    buffer_load_dwordx4 v8, s[12:15], s56 offen lds
    s_and_b32 s57, s57, 7
    s_mul_i32 s56, s57, 196608
    s_add_u32 s56, s56, s49
    s_add_u32 m0, s52, 16384
    s_add_u32 s57, s57, 1
    buffer_load_dwordx4 v8, s[12:15], s56 offen lds
    s_and_b32 s57, s57, 7
    s_mul_i32 s56, s57, 196608
    s_add_u32 s56, s56, s49
    s_add_u32 m0, s52, 20480
    s_add_u32 s57, s57, 1
    buffer_load_dwordx4 v8, s[12:15], s56 offen lds
    s_and_b32 s57, s57, 7
    s_mul_i32 s56, s57, 196608
    s_add_u32 s56, s56, s49
    s_add_u32 m0, s52, 24576
    s_add_u32 s57, s57, 1
    buffer_load_dwordx4 v8, s[12:15], s56 offen lds
    s_and_b32 s57, s57, 7
    s_mul_i32 s56, s57, 196608
    s_add_u32 s56, s56, s49
    s_add_u32 m0, s52, 28672
    s_add_u32 s57, s57, 1
    buffer_load_dwordx4 v8, s[12:15], s56 offen lds
    s_and_b32 s57, s57, 7
    s_waitcnt vmcnt(4)
    ds_read_b64_tr_b16 v[40:41], v11 offset:0
    ds_read_b64_tr_b16 v[42:43], v11 offset:256
    ds_read_b64_tr_b16 v[44:45], v11 offset:4096
    ds_read_b64_tr_b16 v[46:47], v11 offset:4352
    ds_read_b64_tr_b16 v[48:49], v11 offset:8192
    ds_read_b64_tr_b16 v[50:51], v11 offset:8448
    ds_read_b64_tr_b16 v[52:53], v11 offset:12288
    ds_read_b64_tr_b16 v[54:55], v11 offset:12544
    s_waitcnt lgkmcnt(6)
    v_mfma_f32_16x16x32_bf16 v[32:35], v[36:39], v[40:43], 0
    s_waitcnt lgkmcnt(4)
    v_mfma_f32_16x16x32_bf16 v[32:35], v[36:39], v[44:47], v[32:35]
    s_waitcnt lgkmcnt(2)
    v_mfma_f32_16x16x32_bf16 v[32:35], v[36:39], v[48:51], v[32:35]
    s_waitcnt lgkmcnt(0)
    v_mfma_f32_16x16x32_bf16 v[32:35], v[36:39], v[52:55], v[32:35]
    v_cmp_ne_u32 vcc, 0, v15
    s_cmp_eq_u64 vcc, -1
    s_cbranch_scc1 .La_cert
.Lpoll_1:
    buffer_load_dword v7, v9, s[20:23], 0 offen sc1
    s_sub_u32 s45, s45, 1
    s_cbranch_scc0 .Lpoll_1_w
    s_mov_b32 s45, 0
    s_waitcnt vmcnt(0)
    s_branch .Lpoll_1_x
.Lpoll_1_w:
    s_waitcnt vmcnt(0)
    v_cmp_le_u32 vcc, 1, v7
    s_cmp_eq_u64 vcc, -1
    s_cbranch_scc0 .Lpoll_1
.Lpoll_1_x:
.La_cert:
    s_barrier
    s_waitcnt vmcnt(0)
    ds_read_b64_tr_b16 v[56:57], v11 offset:16384
    ds_read_b64_tr_b16 v[58:59], v11 offset:16640
    ds_read_b64_tr_b16 v[60:61], v11 offset:20480
    ds_read_b64_tr_b16 v[62:63], v11 offset:20736
    ds_read_b64_tr_b16 v[64:65], v11 offset:24576
    ds_read_b64_tr_b16 v[66:67], v11 offset:24832
    ds_read_b64_tr_b16 v[68:69], v11 offset:28672
    ds_read_b64_tr_b16 v[70:71], v11 offset:28928
    s_waitcnt lgkmcnt(6)
    v_mfma_f32_16x16x32_bf16 v[32:35], v[36:39], v[56:59], v[32:35]
    s_waitcnt lgkmcnt(4)
    v_mfma_f32_16x16x32_bf16 v[32:35], v[36:39], v[60:63], v[32:35]
    s_waitcnt lgkmcnt(2)
    v_mfma_f32_16x16x32_bf16 v[32:35], v[36:39], v[64:67], v[32:35]
    s_waitcnt lgkmcnt(0)
    v_mfma_f32_16x16x32_bf16 v[32:35], v[36:39], v[68:71], v[32:35]
    s_cmp_lg_u32 s40, 4
    s_cbranch_scc1 .La_noid
    s_lshl_b32 s46, s43, 7
    s_lshl_b32 s47, s44, 2
    s_add_u32 s46, s46, s47
    s_add_u32 s46, s46, 15785984
    s_add_u32 s47, s42, 1
    v_mov_b32 v6, 0
    v_mov_b32 v7, s47
    s_mov_b64 exec, 1
    buffer_store_dword v7, v6, s[4:7], s46 offen sc1
    s_mov_b64 exec, -1
.La_noid:
    s_nop 5
    ds_write_b32 v12, v32 offset:1024
    s_waitcnt lgkmcnt(0)
    s_barrier
    s_lshr_b32 s46, s40, 2
    s_lshl_b32 s46, s46, 11
    v_lshlrev_b32 v2, 4, v1
    v_add_u32 v4, s46, v2
    v_and_b32 v5, 15, v1
    v_lshlrev_b32 v5, 4, v5
    v_lshrrev_b32 v7, 5, v1
    v_lshl_add_u32 v5, v7, 8, v5
    v_add_u32 v5, s46, v5
    v_and_b32 v85, 31, v1
    v_lshlrev_b32 v85, 10, v85
    v_lshl_add_u32 v85, v7, 4, v85
    v_mov_b32 v84, 0xdddddddd
    v_mov_b32 v7, 0x3f803f80
    s_mov_b32 s46, 0x00110000
    s_mov_b32 s47, 0x00110000
    v_cndmask_b32 v20, 0, v7, s[46:47]
    v_cndmask_b32 v21, 0, v7, s[46:47]
    v_mov_b64 v[68:69], 0
    v_mov_b64 v[70:71], 0
    v_mov_b64 v[72:73], 0
    v_mov_b64 v[74:75], 0
    v_mov_b64 v[76:77], 0
    v_mov_b64 v[78:79], 0
    v_mov_b64 v[80:81], 0
    v_mov_b64 v[82:83], 0
    v_mov_b64 v[22:23], v[20:21]
    v_mov_b64 v[24:25], v[20:21]
    v_mov_b64 v[26:27], v[20:21]
    v_mov_b64 v[28:29], v[20:21]
    v_mov_b64 v[30:31], v[20:21]
    v_mov_b64 v[32:33], v[20:21]
    v_mov_b64 v[34:35], v[20:21]
    s_mov_b32 s54, 0xffff
    s_mov_b32 s55, 0xffff
    v_bfe_u32 v3, v1, 2, 3
    v_lshlrev_b32 v3, 10, v3
    v_and_b32 v7, 3, v1
    v_lshl_add_u32 v3, v7, 4, v3
    v_lshrrev_b32 v7, 5, v1
    v_lshl_add_u32 v3, v7, 6, v3
    s_lshl_b32 s46, s40, 4
    s_add_u32 s46, s46, 0
    v_lshrrev_b32 v7, 2, v1
    v_add_u32 v7, s46, v7
    v_mul_u32_u24 v248, 171, v7
    v_lshrrev_b32 v248, 9, v248
    v_mul_u32_u24 v251, 3, v248
    v_sub_u32 v7, v7, v251
    v_mul_u32_u24 v248, 2752, v248
    v_lshl_add_u32 v248, v7, 6, v248
    v_and_b32 v7, 3, v1
    v_lshl_add_u32 v248, v7, 4, v248
    s_lshl_b32 s46, s40, 4
    s_add_u32 s46, s46, 128
    v_lshrrev_b32 v7, 2, v1
    v_add_u32 v7, s46, v7
    v_mul_u32_u24 v249, 171, v7
    v_lshrrev_b32 v249, 9, v249
    v_mul_u32_u24 v251, 3, v249
    v_sub_u32 v7, v7, v251
    v_mul_u32_u24 v249, 2752, v249
    v_lshl_add_u32 v249, v7, 6, v249
    v_and_b32 v7, 3, v1
    v_lshl_add_u32 v249, v7, 4, v249
    s_lshl_b32 s46, s40, 4
    s_add_u32 s46, s46, 256
    v_lshrrev_b32 v7, 2, v1
    v_add_u32 v7, s46, v7
    v_mul_u32_u24 v250, 171, v7
    v_lshrrev_b32 v250, 9, v250
    v_mul_u32_u24 v251, 3, v250
    v_sub_u32 v7, v7, v251
    v_mul_u32_u24 v250, 2752, v250
    v_lshl_add_u32 v250, v7, 6, v250
    v_and_b32 v7, 3, v1
    v_lshl_add_u32 v250, v7, 4, v250
    s_mul_i32 s48, s44, 192
    s_lshl_b32 s37, s40, 10
    s_add_u32 s50, s37, 114688
    s_add_u32 s37, s37, 49152
    s_lshl_b32 s49, s40, 13
    s_and_b32 s46, s44, 7
    s_lshl_b32 s46, s46, 7
    s_add_u32 s49, s49, s46
    s_lshl_b32 s53, s40, 11
    s_lshl_b32 s52, s44, 18
    s_add_u32 s52, s52, s53
    s_add_u32 s51, s43, 2
    s_and_b32 s51, s51, 14
    s_lshl_b32 s51, s51, 14
    s_and_b32 s46, s2, 0xf8
    s_add_u32 s46, s46, s40
    s_mul_i32 s46, s46, 43
    v_min_u32 v251, 42, v1
    v_add_u32 v251, s46, v251
    v_lshlrev_b32 v251, 7, v251
    v_and_b32 v6, 15, v1
    v_lshlrev_b32 v6, 7, v6
    s_lshl_b32 s56, s44, 11
    s_lshl_b32 s46, s36, 2
    s_add_u32 s56, s56, s46
    s_add_u32 s56, s56, 15728640
    s_xor_b32 s46, s43, 1
    s_lshl_b32 s0, 1, s46
    s_lshl_b32 s47, s46, 14
    s_lshr_b32 s46, s51, 14
    s_lshl_b32 s57, 1, s46
    s_mov_b32 s1, 0
    s_or_b32 s0, s0, s57
    s_lshl_b32 s46, s36, 10
    s_add_u32 s46, s46, 155648
    v_add_u32 v86, s46, v2
    s_lshl_b32 s36, s36, 12
    s_lshl_b32 s38, s44, 18
    s_add_u32 s38, s38, s36
    s_add_u32 s39, s51, s38
    s_add_u32 s38, s47, s38
    v_mov_b32 v87, v13
    ds_read_b128 v[12:15], v4
    ds_read_b128 v[16:19], v4 offset:4096
    s_mov_b64 exec, s[54:55]
    ds_read_b128 v[20:23], v5 offset:1024
    ds_read_b128 v[24:27], v5 offset:1536
    s_mov_b64 exec, -1
    s_mov_b64 exec, s[0:1]
.Lpoll_2:
    buffer_load_dword v7, v6, s[4:7], s56 offen sc1
    s_sub_u32 s45, s45, 1
    s_cbranch_scc0 .Lpoll_2_w
    s_mov_b32 s45, 0
    s_waitcnt vmcnt(0)
    s_branch .Lpoll_2_x
.Lpoll_2_w:
    s_waitcnt vmcnt(0)
    v_cmp_le_u32 vcc, 1, v7
    s_andn2_b64 s[46:47], s[0:1], vcc
    s_cbranch_scc1 .Lpoll_2
    s_branch .Lpoll_2_x
    s_cbranch_scc0 .Lpoll_2
.Lpoll_2_x:
    s_mov_b64 exec, -1
    ds_read_b32 v89, v87
    ds_read_b128 v[8:11], v86
    s_add_u32 m0, s36, 16384
    s_nop 0
    buffer_load_dwordx4 v2, s[4:7], s38 offen sc1 lds
    buffer_load_dwordx4 v2, s[4:7], s38 offen offset:1024 sc1 lds
    buffer_load_dwordx4 v2, s[4:7], s38 offen offset:2048 sc1 lds
    buffer_load_dwordx4 v2, s[4:7], s38 offen offset:3072 sc1 lds
    s_waitcnt lgkmcnt(0)
    v_cmp_ne_u32 vcc, 0, v89
    s_cbranch_vccz .La_q
    s_branch .Lb0q
.La_q:
    ds_read_b32 v89, v87
    ds_read_b128 v[8:11], v86
    s_sub_u32 s45, s45, 1
    s_cselect_b32 s45, 0, s45
    s_cbranch_scc1 .Lb0
    s_waitcnt lgkmcnt(0)
    v_cmp_ne_u32 vcc, 0, v89
    s_cbranch_vccz .La_q
    s_branch .Lb0
.La_mfma:
    v_lshlrev_b32 v2, 4, v1
    s_waitcnt lgkmcnt(0)
    s_cmp_ge_u32 s2, 8
    s_cbranch_scc1 .La_nozero
    v_mov_b32 v36, 0
    v_mov_b32 v37, 0
    v_mov_b32 v38, 0
    v_mov_b32 v39, 0
    s_lshl_b32 s46, s2, 2
    s_add_u32 s46, s46, s40
    s_lshl_b32 s46, s46, 11
    s_add_u32 s46, s46, 15728640
    buffer_store_dwordx4 v[36:39], v2, s[4:7], s46 offen offset:0 sc1
    buffer_store_dwordx4 v[36:39], v2, s[4:7], s46 offen offset:1024 sc1
.La_nozero:
    s_lshr_b32 s0, s12, 7
    s_sub_u32 s0, 3, s0
    s_and_b32 s0, s0, 7
    s_lshr_b32 s1, s2, 3
    s_add_u32 s3, s0, s2
    s_add_u32 s3, s3, 6
    s_lshl_b32 s3, s3, 6
    s_mul_i32 s36, s1, 12
    s_add_u32 s3, s3, s36
    s_lshl_b32 s1, s1, 4
    s_sub_u32 s1, s1, 32
    v_lshrrev_b32 v240, 1, v1
    v_add_u32 v240, s3, v240
    v_and_b32 v240, 511, v240
    v_mul_u32_u24 v240, 3, v240
    v_and_b32 v7, 1, v1
    v_add3_u32 v240, v240, v7, 1
    v_add_u32 v7, s1, v1
    v_mul_u32_u24 v7, 3, v7
    v_cmp_gt_u32 vcc, 32, v1
    s_lshl_b32 s0, s0, 7
    s_cmp_eq_u32 s40, 2
    s_cselect_b32 s36, 0xffffff, 0
    s_cselect_b32 s37, 0x0, 0
    v_cndmask_b32 v240, v7, v240, vcc
    v_lshlrev_b32 v240, 10, v240
    v_and_b32 v10, 31, v1
    v_lshrrev_b32 v9, 5, v1
    v_bfe_u32 v14, v1, 1, 3
    v_xor_b32 v14, v14, v9
    s_mul_i32 s46, s40, 12288
    s_add_u32 s46, s46, 16384
    v_lshl_add_u32 v15, v10, 7, s46
    v_xor_b32 v7, 0, v14
    v_lshl_add_u32 v2, v7, 4, v15
    v_xor_b32 v7, 2, v14
    v_lshl_add_u32 v3, v7, 4, v15
    v_xor_b32 v7, 4, v14
    v_lshl_add_u32 v4, v7, 4, v15
    v_xor_b32 v7, 6, v14
    v_lshl_add_u32 v5, v7, 4, v15
    v_bfe_u32 v6, v1, 2, 2
    v_lshrrev_b32 v7, 5, v1
    v_lshl_add_u32 v6, v7, 3, v6
    v_lshlrev_b32 v6, 6, v6
    v_bfe_u32 v7, v1, 4, 1
    v_lshl_add_u32 v6, v7, 5, v6
    v_and_b32 v7, 3, v1
    v_lshl_add_u32 v6, v7, 3, v6
    v_add_u32 v6, 65536, v6
    v_mov_b32 v7, 0x3f803f80
    s_mov_b32 s46, 0x10100101
    s_mov_b32 s47, 0x10100101
    v_cndmask_b32 v88, 0, v7, s[46:47]
    v_cndmask_b32 v89, 0, v7, s[46:47]
    v_cndmask_b32 v90, 0, v7, s[46:47]
    v_cndmask_b32 v91, 0, v7, s[46:47]
    v_lshlrev_b32 v10, 4, v10
    v_add_u32 v10, 159744, v10
    s_mov_b32 s46, -1
    s_mov_b32 s47, 0
    v_cndmask_b32 v24, 0, v7, s[46:47]
    v_mov_b32 v7, 0xbb000000
    v_cndmask_b32 v11, 0, v7, s[46:47]
    v_mov_b32 v14, 0
    v_mov_b32 v15, 0
    v_mov_b32 v18, 0
    v_mov_b32 v19, 0
    v_mov_b32 v21, 0
    v_mov_b32 v22, 0
    v_mov_b32 v23, 0
    v_mov_b32 v25, 0
    v_mov_b32 v26, 0
    v_mov_b32 v27, 0
    v_mov_b32 v94, 0
    v_mov_b32 v95, 0
    v_and_b32 v8, 0x33, v1
    v_bfe_u32 v7, v1, 2, 1
    v_lshl_or_b32 v8, v7, 3, v8
    v_bfe_u32 v7, v1, 3, 1
    v_lshl_or_b32 v8, v7, 2, v8
    v_lshlrev_b32 v8, 4, v8
    v_lshlrev_b32 v9, 8, v9
    v_and_b32 v7, 15, v1
    v_lshl_add_u32 v9, v7, 4, v9
    v_bfe_u32 v7, v1, 4, 1
    v_lshl_add_u32 v9, v7, 11, v9
    s_lshl_b32 s46, s40, 12
    v_add_u32 v8, s46, v8
    v_add_u32 v9, s46, v9
    s_lshl_b32 s56, s44, 18
    s_lshl_b32 s47, s43, 14
    s_add_u32 s56, s56, s47
    s_cmp_ge_u32 s2, 8
    s_cbranch_scc1 .La_nocert
    s_waitcnt vmcnt(0)
    s_lshl_b32 s46, s2, 2
    s_add_u32 s46, s46, s40
    s_lshl_b32 s46, s46, 2
    v_mov_b32 v28, 0
    v_mov_b32 v29, 1
    s_mov_b64 exec, 1
    buffer_store_dword v29, v28, s[20:23], s46 offen sc1
    s_mov_b64 exec, -1
.La_nocert:
    v_bfe_u32 v92, v1, 3, 2
    v_mul_u32_u24 v92, 3072, v92
    v_and_b32 v7, 7, v1
    v_lshl_add_u32 v92, v7, 7, v92
    s_lshr_b32 s46, s2, 3
    s_lshl_b32 s47, s2, 2
    s_add_u32 s46, s46, s47
    s_and_b32 s46, s46, 31
    s_lshl_b32 s46, s46, 2
    s_add_u32 s46, s46, s40
    s_mul_i32 s57, s46, 12288
    s_mov_b32 s46, 0xaaaaaaaa
    s_mov_b32 s47, 0xaaaaaaaa
    s_mov_b32 s48, 0xcccccccc
    s_mov_b32 s49, 0xcccccccc
    s_mov_b32 s50, 0xff00ff00
    s_mov_b32 s51, 0xff00ff00
    s_mov_b32 s52, 0xffff0000
    s_mov_b32 s53, 0xffff0000
    s_mov_b32 s54, 0xf0f0f0f0
    s_mov_b32 s55, 0xf0f0f0f0
    s_barrier
    s_cmp_eq_u32 s36, 0
    s_cbranch_scc1 .Lsl_3
    s_mov_b64 exec, s[36:37]
    buffer_load_dword v0, v240, s[12:15], s0 offen
    s_mov_b64 exec, -1
.Lsl_3:
    ds_read_b128 v[96:99], v2 offset:0
    ds_read_b64_tr_b16 v[224:225], v6 offset:0
    ds_read_b64_tr_b16 v[226:227], v6 offset:256
    ds_read_b64_tr_b16 v[228:229], v6 offset:1024
    ds_read_b64_tr_b16 v[230:231], v6 offset:1280
    ds_read_b128 v[100:103], v3 offset:0
    ds_read_b64_tr_b16 v[232:233], v6 offset:2048
    ds_read_b64_tr_b16 v[234:235], v6 offset:2304
    ds_read_b64_tr_b16 v[236:237], v6 offset:3072
    ds_read_b64_tr_b16 v[238:239], v6 offset:3328
    ds_read_b128 v[104:107], v4 offset:0
    ds_read_b64_tr_b16 v[240:241], v6 offset:4096
    ds_read_b64_tr_b16 v[242:243], v6 offset:4352
    ds_read_b64_tr_b16 v[244:245], v6 offset:5120
    ds_read_b64_tr_b16 v[246:247], v6 offset:5376
    s_waitcnt lgkmcnt(14)
    v_mfma_f32_4x4x4_16b_bf16 v[68:71], v[96:97], v[96:97], 0
    v_mfma_f32_4x4x4_16b_bf16 v[72:75], v[98:99], v[98:99], 0
    s_waitcnt lgkmcnt(12)
    v_mfma_f32_32x32x16_bf16 v[36:51], v[224:227], v[96:99], 0
    v_mfma_f32_16x16x32_bf16 v[84:87], v[88:91], v[96:99], 0
    s_waitcnt lgkmcnt(10)
    v_mfma_f32_32x32x16_bf16 v[52:67], v[96:99], v[228:231], 0
    s_waitcnt lgkmcnt(9)
    v_mfma_f32_4x4x4_16b_bf16 v[68:71], v[100:101], v[100:101], v[68:71]
    v_mfma_f32_4x4x4_16b_bf16 v[72:75], v[102:103], v[102:103], v[72:75]
    ds_read_b128 v[108:111], v5 offset:0
    ds_read_b64_tr_b16 v[248:249], v6 offset:6144
    ds_read_b64_tr_b16 v[250:251], v6 offset:6400
    ds_read_b64_tr_b16 v[252:253], v6 offset:7168
    ds_read_b64_tr_b16 v[254:255], v6 offset:7424
    s_waitcnt lgkmcnt(12)
    v_mfma_f32_32x32x16_bf16 v[36:51], v[232:235], v[100:103], v[36:51]
    v_mfma_f32_16x16x32_bf16 v[84:87], v[88:91], v[100:103], v[84:87]
    s_waitcnt lgkmcnt(10)
    v_mfma_f32_32x32x16_bf16 v[52:67], v[100:103], v[236:239], v[52:67]
    s_waitcnt lgkmcnt(0)
    s_barrier
    ds_read_b128 v[112:115], v2 offset:4096
    ds_read_b64_tr_b16 v[224:225], v6 offset:8192
    ds_read_b64_tr_b16 v[226:227], v6 offset:8448
    ds_read_b64_tr_b16 v[228:229], v6 offset:9216
    ds_read_b64_tr_b16 v[230:231], v6 offset:9472
    ds_read_b128 v[116:119], v3 offset:4096
    ds_read_b64_tr_b16 v[232:233], v6 offset:10240
    ds_read_b64_tr_b16 v[234:235], v6 offset:10496
    ds_read_b64_tr_b16 v[236:237], v6 offset:11264
    ds_read_b64_tr_b16 v[238:239], v6 offset:11520
    v_mfma_f32_4x4x4_16b_bf16 v[68:71], v[104:105], v[104:105], v[68:71]
    v_mfma_f32_4x4x4_16b_bf16 v[72:75], v[106:107], v[106:107], v[72:75]
    v_mfma_f32_32x32x16_bf16 v[36:51], v[240:243], v[104:107], v[36:51]
    v_mfma_f32_16x16x32_bf16 v[84:87], v[88:91], v[104:107], v[84:87]
    v_mfma_f32_32x32x16_bf16 v[52:67], v[104:107], v[244:247], v[52:67]
    v_mfma_f32_4x4x4_16b_bf16 v[68:71], v[108:109], v[108:109], v[68:71]
    v_mfma_f32_4x4x4_16b_bf16 v[72:75], v[110:111], v[110:111], v[72:75]
    ds_read_b128 v[120:123], v4 offset:4096
    ds_read_b64_tr_b16 v[240:241], v6 offset:12288
    ds_read_b64_tr_b16 v[242:243], v6 offset:12544
    ds_read_b64_tr_b16 v[244:245], v6 offset:13312
    ds_read_b64_tr_b16 v[246:247], v6 offset:13568
    v_mfma_f32_32x32x16_bf16 v[36:51], v[248:251], v[108:111], v[36:51]
    v_mfma_f32_16x16x32_bf16 v[84:87], v[88:91], v[108:111], v[84:87]
    v_mfma_f32_32x32x16_bf16 v[52:67], v[108:111], v[252:255], v[52:67]
    s_waitcnt lgkmcnt(14)
    v_mfma_f32_4x4x4_16b_bf16 v[68:71], v[112:113], v[112:113], v[68:71]
    v_mfma_f32_4x4x4_16b_bf16 v[72:75], v[114:115], v[114:115], v[72:75]
    ds_read_b128 v[124:127], v5 offset:4096
    ds_read_b64_tr_b16 v[248:249], v6 offset:14336
    ds_read_b64_tr_b16 v[250:251], v6 offset:14592
    ds_read_b64_tr_b16 v[252:253], v6 offset:15360
    ds_read_b64_tr_b16 v[254:255], v6 offset:15616
    s_waitcnt lgkmcnt(15)
    v_mfma_f32_32x32x16_bf16 v[36:51], v[224:227], v[112:115], v[36:51]
    v_mfma_f32_16x16x32_bf16 v[84:87], v[88:91], v[112:115], v[84:87]
    v_mfma_f32_32x32x16_bf16 v[52:67], v[112:115], v[228:231], v[52:67]
    s_waitcnt lgkmcnt(14)
    v_mfma_f32_4x4x4_16b_bf16 v[68:71], v[116:117], v[116:117], v[68:71]
    v_mfma_f32_4x4x4_16b_bf16 v[72:75], v[118:119], v[118:119], v[72:75]
    s_waitcnt lgkmcnt(12)
    v_mfma_f32_32x32x16_bf16 v[36:51], v[232:235], v[116:119], v[36:51]
    v_mfma_f32_16x16x32_bf16 v[84:87], v[88:91], v[116:119], v[84:87]
    s_waitcnt lgkmcnt(10)
    v_mfma_f32_32x32x16_bf16 v[52:67], v[116:119], v[236:239], v[52:67]
    s_waitcnt lgkmcnt(0)
    s_barrier
    ds_read_b128 v[128:131], v2 offset:8192
    ds_read_b64_tr_b16 v[224:225], v6 offset:16384
    ds_read_b64_tr_b16 v[226:227], v6 offset:16640
    ds_read_b64_tr_b16 v[228:229], v6 offset:17408
    ds_read_b64_tr_b16 v[230:231], v6 offset:17664
    ds_read_b128 v[132:135], v3 offset:8192
    ds_read_b64_tr_b16 v[232:233], v6 offset:18432
    ds_read_b64_tr_b16 v[234:235], v6 offset:18688
    ds_read_b64_tr_b16 v[236:237], v6 offset:19456
    ds_read_b64_tr_b16 v[238:239], v6 offset:19712
    v_mfma_f32_4x4x4_16b_bf16 v[68:71], v[120:121], v[120:121], v[68:71]
    v_mfma_f32_4x4x4_16b_bf16 v[72:75], v[122:123], v[122:123], v[72:75]
    v_mfma_f32_32x32x16_bf16 v[36:51], v[240:243], v[120:123], v[36:51]
    v_mfma_f32_16x16x32_bf16 v[84:87], v[88:91], v[120:123], v[84:87]
    v_mfma_f32_32x32x16_bf16 v[52:67], v[120:123], v[244:247], v[52:67]
    v_mfma_f32_4x4x4_16b_bf16 v[68:71], v[124:125], v[124:125], v[68:71]
    v_mfma_f32_4x4x4_16b_bf16 v[72:75], v[126:127], v[126:127], v[72:75]
    ds_read_b128 v[136:139], v4 offset:8192
    ds_read_b64_tr_b16 v[240:241], v6 offset:20480
    ds_read_b64_tr_b16 v[242:243], v6 offset:20736
    ds_read_b64_tr_b16 v[244:245], v6 offset:21504
    ds_read_b64_tr_b16 v[246:247], v6 offset:21760
    v_mfma_f32_32x32x16_bf16 v[36:51], v[248:251], v[124:127], v[36:51]
    v_mfma_f32_16x16x32_bf16 v[84:87], v[88:91], v[124:127], v[84:87]
    v_mfma_f32_32x32x16_bf16 v[52:67], v[124:127], v[252:255], v[52:67]
    s_waitcnt lgkmcnt(14)
    v_mfma_f32_4x4x4_16b_bf16 v[68:71], v[128:129], v[128:129], v[68:71]
    v_mfma_f32_4x4x4_16b_bf16 v[72:75], v[130:131], v[130:131], v[72:75]
    ds_read_b128 v[140:143], v5 offset:8192
    ds_read_b64_tr_b16 v[248:249], v6 offset:22528
    ds_read_b64_tr_b16 v[250:251], v6 offset:22784
    ds_read_b64_tr_b16 v[252:253], v6 offset:23552
    ds_read_b64_tr_b16 v[254:255], v6 offset:23808
    s_waitcnt lgkmcnt(15)
    v_mfma_f32_32x32x16_bf16 v[36:51], v[224:227], v[128:131], v[36:51]
    v_mfma_f32_16x16x32_bf16 v[84:87], v[88:91], v[128:131], v[84:87]
    v_mfma_f32_32x32x16_bf16 v[52:67], v[128:131], v[228:231], v[52:67]
    s_waitcnt lgkmcnt(14)
    v_mfma_f32_4x4x4_16b_bf16 v[68:71], v[132:133], v[132:133], v[68:71]
    v_mfma_f32_4x4x4_16b_bf16 v[72:75], v[134:135], v[134:135], v[72:75]
    s_waitcnt lgkmcnt(12)
    v_mfma_f32_32x32x16_bf16 v[36:51], v[232:235], v[132:135], v[36:51]
    v_mfma_f32_16x16x32_bf16 v[84:87], v[88:91], v[132:135], v[84:87]
    s_waitcnt lgkmcnt(10)
    v_mfma_f32_32x32x16_bf16 v[52:67], v[132:135], v[236:239], v[52:67]
    s_waitcnt lgkmcnt(0)
    s_barrier
    ds_read_b128 v[144:147], v2 offset:0
    ds_read_b64_tr_b16 v[224:225], v6 offset:24576
    ds_read_b64_tr_b16 v[226:227], v6 offset:24832
    ds_read_b64_tr_b16 v[228:229], v6 offset:25600
    ds_read_b64_tr_b16 v[230:231], v6 offset:25856
    ds_read_b128 v[148:151], v3 offset:0
    ds_read_b64_tr_b16 v[232:233], v6 offset:26624
    ds_read_b64_tr_b16 v[234:235], v6 offset:26880
    ds_read_b64_tr_b16 v[236:237], v6 offset:27648
    ds_read_b64_tr_b16 v[238:239], v6 offset:27904
    v_mfma_f32_4x4x4_16b_bf16 v[68:71], v[136:137], v[136:137], v[68:71]
    v_mfma_f32_4x4x4_16b_bf16 v[72:75], v[138:139], v[138:139], v[72:75]
    v_mfma_f32_32x32x16_bf16 v[36:51], v[240:243], v[136:139], v[36:51]
    v_mfma_f32_16x16x32_bf16 v[84:87], v[88:91], v[136:139], v[84:87]
    v_mfma_f32_32x32x16_bf16 v[52:67], v[136:139], v[244:247], v[52:67]
    v_mfma_f32_4x4x4_16b_bf16 v[68:71], v[140:141], v[140:141], v[68:71]
    v_mfma_f32_4x4x4_16b_bf16 v[72:75], v[142:143], v[142:143], v[72:75]
    ds_read_b128 v[152:155], v4 offset:0
    ds_read_b64_tr_b16 v[240:241], v6 offset:28672
    ds_read_b64_tr_b16 v[242:243], v6 offset:28928
    ds_read_b64_tr_b16 v[244:245], v6 offset:29696
    ds_read_b64_tr_b16 v[246:247], v6 offset:29952
    v_mfma_f32_32x32x16_bf16 v[36:51], v[248:251], v[140:143], v[36:51]
    v_mfma_f32_16x16x32_bf16 v[84:87], v[88:91], v[140:143], v[84:87]
    v_mfma_f32_32x32x16_bf16 v[52:67], v[140:143], v[252:255], v[52:67]
    s_waitcnt lgkmcnt(14)
    v_mfma_f32_4x4x4_16b_bf16 v[68:71], v[144:145], v[144:145], v[68:71]
    v_mfma_f32_4x4x4_16b_bf16 v[72:75], v[146:147], v[146:147], v[72:75]
    ds_read_b128 v[156:159], v5 offset:0
    ds_read_b64_tr_b16 v[248:249], v6 offset:30720
    ds_read_b64_tr_b16 v[250:251], v6 offset:30976
    ds_read_b64_tr_b16 v[252:253], v6 offset:31744
    ds_read_b64_tr_b16 v[254:255], v6 offset:32000
    s_waitcnt lgkmcnt(15)
    v_mfma_f32_32x32x16_bf16 v[36:51], v[224:227], v[144:147], v[36:51]
    v_mfma_f32_16x16x32_bf16 v[84:87], v[88:91], v[144:147], v[84:87]
    v_mfma_f32_32x32x16_bf16 v[52:67], v[144:147], v[228:231], v[52:67]
    s_waitcnt lgkmcnt(14)
    v_mfma_f32_4x4x4_16b_bf16 v[68:71], v[148:149], v[148:149], v[68:71]
    v_mfma_f32_4x4x4_16b_bf16 v[72:75], v[150:151], v[150:151], v[72:75]
    s_waitcnt lgkmcnt(12)
    v_mfma_f32_32x32x16_bf16 v[36:51], v[232:235], v[148:151], v[36:51]
    v_mfma_f32_16x16x32_bf16 v[84:87], v[88:91], v[148:151], v[84:87]
    s_waitcnt lgkmcnt(10)
    v_mfma_f32_32x32x16_bf16 v[52:67], v[148:151], v[236:239], v[52:67]
    s_waitcnt lgkmcnt(0)
    s_barrier
    ds_read_b128 v[160:163], v2 offset:4096
    ds_read_b64_tr_b16 v[224:225], v6 offset:0
    ds_read_b64_tr_b16 v[226:227], v6 offset:256
    ds_read_b64_tr_b16 v[228:229], v6 offset:1024
    ds_read_b64_tr_b16 v[230:231], v6 offset:1280
    ds_read_b128 v[164:167], v3 offset:4096
    ds_read_b64_tr_b16 v[232:233], v6 offset:2048
    ds_read_b64_tr_b16 v[234:235], v6 offset:2304
    ds_read_b64_tr_b16 v[236:237], v6 offset:3072
    ds_read_b64_tr_b16 v[238:239], v6 offset:3328
    v_mfma_f32_4x4x4_16b_bf16 v[68:71], v[152:153], v[152:153], v[68:71]
    v_mfma_f32_4x4x4_16b_bf16 v[72:75], v[154:155], v[154:155], v[72:75]
    v_mfma_f32_32x32x16_bf16 v[36:51], v[240:243], v[152:155], v[36:51]
    v_mfma_f32_16x16x32_bf16 v[84:87], v[88:91], v[152:155], v[84:87]
    v_mfma_f32_32x32x16_bf16 v[52:67], v[152:155], v[244:247], v[52:67]
    v_mfma_f32_4x4x4_16b_bf16 v[68:71], v[156:157], v[156:157], v[68:71]
    v_mfma_f32_4x4x4_16b_bf16 v[72:75], v[158:159], v[158:159], v[72:75]
    ds_read_b128 v[168:171], v4 offset:4096
    ds_read_b64_tr_b16 v[240:241], v6 offset:4096
    ds_read_b64_tr_b16 v[242:243], v6 offset:4352
    ds_read_b64_tr_b16 v[244:245], v6 offset:5120
    ds_read_b64_tr_b16 v[246:247], v6 offset:5376
    v_mfma_f32_32x32x16_bf16 v[36:51], v[248:251], v[156:159], v[36:51]
    v_mfma_f32_16x16x32_bf16 v[84:87], v[88:91], v[156:159], v[84:87]
    v_mfma_f32_32x32x16_bf16 v[52:67], v[156:159], v[252:255], v[52:67]
    s_waitcnt lgkmcnt(14)
    v_mfma_f32_4x4x4_16b_bf16 v[68:71], v[160:161], v[160:161], v[68:71]
    v_mfma_f32_4x4x4_16b_bf16 v[72:75], v[162:163], v[162:163], v[72:75]
    ds_read_b128 v[172:175], v5 offset:4096
    ds_read_b64_tr_b16 v[248:249], v6 offset:6144
    ds_read_b64_tr_b16 v[250:251], v6 offset:6400
    ds_read_b64_tr_b16 v[252:253], v6 offset:7168
    ds_read_b64_tr_b16 v[254:255], v6 offset:7424
    s_waitcnt lgkmcnt(15)
    v_mfma_f32_32x32x16_bf16 v[36:51], v[224:227], v[160:163], v[36:51]
    v_mfma_f32_16x16x32_bf16 v[84:87], v[88:91], v[160:163], v[84:87]
    v_mfma_f32_32x32x16_bf16 v[52:67], v[160:163], v[228:231], v[52:67]
    s_waitcnt lgkmcnt(14)
    v_mfma_f32_4x4x4_16b_bf16 v[68:71], v[164:165], v[164:165], v[68:71]
    v_mfma_f32_4x4x4_16b_bf16 v[72:75], v[166:167], v[166:167], v[72:75]
    s_waitcnt lgkmcnt(12)
    v_mfma_f32_32x32x16_bf16 v[36:51], v[232:235], v[164:167], v[36:51]
    v_mfma_f32_16x16x32_bf16 v[84:87], v[88:91], v[164:167], v[84:87]
    s_waitcnt lgkmcnt(10)
    v_mfma_f32_32x32x16_bf16 v[52:67], v[164:167], v[236:239], v[52:67]
    s_waitcnt lgkmcnt(0)
    s_barrier
    ds_read_b128 v[176:179], v2 offset:8192
    ds_read_b64_tr_b16 v[224:225], v6 offset:8192
    ds_read_b64_tr_b16 v[226:227], v6 offset:8448
    ds_read_b64_tr_b16 v[228:229], v6 offset:9216
    ds_read_b64_tr_b16 v[230:231], v6 offset:9472
    ds_read_b128 v[180:183], v3 offset:8192
    ds_read_b64_tr_b16 v[232:233], v6 offset:10240
    ds_read_b64_tr_b16 v[234:235], v6 offset:10496
    ds_read_b64_tr_b16 v[236:237], v6 offset:11264
    ds_read_b64_tr_b16 v[238:239], v6 offset:11520
    buffer_load_dword v0, v92, s[12:15], s57 offen
    v_mfma_f32_4x4x4_16b_bf16 v[68:71], v[168:169], v[168:169], v[68:71]
    v_mfma_f32_4x4x4_16b_bf16 v[72:75], v[170:171], v[170:171], v[72:75]
    v_mfma_f32_32x32x16_bf16 v[36:51], v[240:243], v[168:171], v[36:51]
    v_mfma_f32_16x16x32_bf16 v[84:87], v[88:91], v[168:171], v[84:87]
    v_mfma_f32_32x32x16_bf16 v[52:67], v[168:171], v[244:247], v[52:67]
    v_mfma_f32_4x4x4_16b_bf16 v[68:71], v[172:173], v[172:173], v[68:71]
    v_mfma_f32_4x4x4_16b_bf16 v[72:75], v[174:175], v[174:175], v[72:75]
    ds_read_b128 v[184:187], v4 offset:8192
    ds_read_b64_tr_b16 v[240:241], v6 offset:12288
    ds_read_b64_tr_b16 v[242:243], v6 offset:12544
    ds_read_b64_tr_b16 v[244:245], v6 offset:13312
    ds_read_b64_tr_b16 v[246:247], v6 offset:13568
    v_mfma_f32_32x32x16_bf16 v[36:51], v[248:251], v[172:175], v[36:51]
    v_mfma_f32_16x16x32_bf16 v[84:87], v[88:91], v[172:175], v[84:87]
    v_mfma_f32_32x32x16_bf16 v[52:67], v[172:175], v[252:255], v[52:67]
    s_waitcnt lgkmcnt(14)
    v_mfma_f32_4x4x4_16b_bf16 v[68:71], v[176:177], v[176:177], v[68:71]
    v_mfma_f32_4x4x4_16b_bf16 v[72:75], v[178:179], v[178:179], v[72:75]
    ds_read_b128 v[188:191], v5 offset:8192
    ds_read_b64_tr_b16 v[248:249], v6 offset:14336
    ds_read_b64_tr_b16 v[250:251], v6 offset:14592
    ds_read_b64_tr_b16 v[252:253], v6 offset:15360
    ds_read_b64_tr_b16 v[254:255], v6 offset:15616
    s_waitcnt lgkmcnt(15)
    v_mfma_f32_32x32x16_bf16 v[36:51], v[224:227], v[176:179], v[36:51]
    v_mfma_f32_16x16x32_bf16 v[84:87], v[88:91], v[176:179], v[84:87]
    v_mfma_f32_32x32x16_bf16 v[52:67], v[176:179], v[228:231], v[52:67]
    s_waitcnt lgkmcnt(14)
    v_mfma_f32_4x4x4_16b_bf16 v[68:71], v[180:181], v[180:181], v[68:71]
    v_mfma_f32_4x4x4_16b_bf16 v[72:75], v[182:183], v[182:183], v[72:75]
    s_waitcnt lgkmcnt(12)
    v_mfma_f32_32x32x16_bf16 v[36:51], v[232:235], v[180:183], v[36:51]
    v_mfma_f32_16x16x32_bf16 v[84:87], v[88:91], v[180:183], v[84:87]
    s_waitcnt lgkmcnt(10)
    v_mfma_f32_32x32x16_bf16 v[52:67], v[180:183], v[236:239], v[52:67]
    s_waitcnt lgkmcnt(0)
    s_barrier
    ds_read_b128 v[192:195], v2 offset:0
    ds_read_b64_tr_b16 v[224:225], v6 offset:16384
    ds_read_b64_tr_b16 v[226:227], v6 offset:16640
    ds_read_b64_tr_b16 v[228:229], v6 offset:17408
    ds_read_b64_tr_b16 v[230:231], v6 offset:17664
    ds_read_b128 v[196:199], v3 offset:0
    ds_read_b64_tr_b16 v[232:233], v6 offset:18432
    ds_read_b64_tr_b16 v[234:235], v6 offset:18688
    ds_read_b64_tr_b16 v[236:237], v6 offset:19456
    ds_read_b64_tr_b16 v[238:239], v6 offset:19712
    v_mfma_f32_4x4x4_16b_bf16 v[68:71], v[184:185], v[184:185], v[68:71]
    v_mfma_f32_4x4x4_16b_bf16 v[72:75], v[186:187], v[186:187], v[72:75]
    v_mfma_f32_32x32x16_bf16 v[36:51], v[240:243], v[184:187], v[36:51]
    v_mfma_f32_16x16x32_bf16 v[84:87], v[88:91], v[184:187], v[84:87]
    v_mfma_f32_32x32x16_bf16 v[52:67], v[184:187], v[244:247], v[52:67]
    v_mfma_f32_4x4x4_16b_bf16 v[68:71], v[188:189], v[188:189], v[68:71]
    v_mfma_f32_4x4x4_16b_bf16 v[72:75], v[190:191], v[190:191], v[72:75]
    ds_read_b128 v[200:203], v4 offset:0
    ds_read_b64_tr_b16 v[240:241], v6 offset:20480
    ds_read_b64_tr_b16 v[242:243], v6 offset:20736
    ds_read_b64_tr_b16 v[244:245], v6 offset:21504
    ds_read_b64_tr_b16 v[246:247], v6 offset:21760
    v_mfma_f32_32x32x16_bf16 v[36:51], v[248:251], v[188:191], v[36:51]
    v_mfma_f32_16x16x32_bf16 v[84:87], v[88:91], v[188:191], v[84:87]
    v_mfma_f32_32x32x16_bf16 v[52:67], v[188:191], v[252:255], v[52:67]
    s_waitcnt lgkmcnt(14)
    v_mfma_f32_4x4x4_16b_bf16 v[68:71], v[192:193], v[192:193], v[68:71]
    v_mfma_f32_4x4x4_16b_bf16 v[72:75], v[194:195], v[194:195], v[72:75]
    ds_read_b128 v[204:207], v5 offset:0
    ds_read_b64_tr_b16 v[248:249], v6 offset:22528
    ds_read_b64_tr_b16 v[250:251], v6 offset:22784
    ds_read_b64_tr_b16 v[252:253], v6 offset:23552
    ds_read_b64_tr_b16 v[254:255], v6 offset:23808
    s_waitcnt lgkmcnt(15)
    v_mfma_f32_32x32x16_bf16 v[36:51], v[224:227], v[192:195], v[36:51]
    v_mfma_f32_16x16x32_bf16 v[84:87], v[88:91], v[192:195], v[84:87]
    v_mfma_f32_32x32x16_bf16 v[52:67], v[192:195], v[228:231], v[52:67]
    s_waitcnt lgkmcnt(14)
    v_mfma_f32_4x4x4_16b_bf16 v[68:71], v[196:197], v[196:197], v[68:71]
    v_mfma_f32_4x4x4_16b_bf16 v[72:75], v[198:199], v[198:199], v[72:75]
    s_waitcnt lgkmcnt(12)
    v_mfma_f32_32x32x16_bf16 v[36:51], v[232:235], v[196:199], v[36:51]
    v_mfma_f32_16x16x32_bf16 v[84:87], v[88:91], v[196:199], v[84:87]
    s_waitcnt lgkmcnt(10)
    v_mfma_f32_32x32x16_bf16 v[52:67], v[196:199], v[236:239], v[52:67]
    s_waitcnt lgkmcnt(9)
    v_mfma_f32_4x4x4_16b_bf16 v[68:71], v[200:201], v[200:201], v[68:71]
    v_mfma_f32_4x4x4_16b_bf16 v[72:75], v[202:203], v[202:203], v[72:75]
    s_waitcnt lgkmcnt(7)
    v_mfma_f32_32x32x16_bf16 v[36:51], v[240:243], v[200:203], v[36:51]
    v_mfma_f32_16x16x32_bf16 v[84:87], v[88:91], v[200:203], v[84:87]
    s_waitcnt lgkmcnt(5)
    v_mfma_f32_32x32x16_bf16 v[52:67], v[200:203], v[244:247], v[52:67]
    s_waitcnt lgkmcnt(4)
    v_mfma_f32_4x4x4_16b_bf16 v[68:71], v[204:205], v[204:205], v[68:71]
    v_mfma_f32_4x4x4_16b_bf16 v[72:75], v[206:207], v[206:207], v[72:75]
    s_waitcnt lgkmcnt(2)
    v_mfma_f32_32x32x16_bf16 v[36:51], v[248:251], v[204:207], v[36:51]
    v_mfma_f32_16x16x32_bf16 v[84:87], v[88:91], v[204:207], v[84:87]
    s_waitcnt lgkmcnt(0)
    v_mfma_f32_32x32x16_bf16 v[52:67], v[204:207], v[252:255], v[52:67]
    s_barrier
    ds_read_b128 v[208:211], v2 offset:4096
    ds_read_b128 v[212:215], v3 offset:4096
    ds_read_b128 v[216:219], v4 offset:4096
    ds_read_b128 v[220:223], v5 offset:4096
    ds_read_b64_tr_b16 v[224:225], v6 offset:24576
    ds_read_b64_tr_b16 v[226:227], v6 offset:24832
    ds_read_b64_tr_b16 v[228:229], v6 offset:25600
    ds_read_b64_tr_b16 v[230:231], v6 offset:25856
    ds_read_b64_tr_b16 v[232:233], v6 offset:26624
    ds_read_b64_tr_b16 v[234:235], v6 offset:26880
    ds_read_b64_tr_b16 v[236:237], v6 offset:27648
    ds_read_b64_tr_b16 v[238:239], v6 offset:27904
    s_waitcnt lgkmcnt(11)
    v_mfma_f32_4x4x4_16b_bf16 v[68:71], v[208:209], v[208:209], v[68:71]
    v_mfma_f32_4x4x4_16b_bf16 v[72:75], v[210:211], v[210:211], v[72:75]
    ds_read_b128 v[28:31], v10
    ds_read_b128 v[32:35], v10 offset:512
    v_mfma_f32_16x16x32_bf16 v[84:87], v[88:91], v[208:211], v[84:87]
    s_waitcnt lgkmcnt(12)
    v_mfma_f32_4x4x4_16b_bf16 v[68:71], v[212:213], v[212:213], v[68:71]
    v_mfma_f32_4x4x4_16b_bf16 v[72:75], v[214:215], v[214:215], v[72:75]
    v_mfma_f32_16x16x32_bf16 v[84:87], v[88:91], v[212:215], v[84:87]
    s_waitcnt lgkmcnt(11)
    v_mfma_f32_4x4x4_16b_bf16 v[68:71], v[216:217], v[216:217], v[68:71]
    v_mfma_f32_4x4x4_16b_bf16 v[72:75], v[218:219], v[218:219], v[72:75]
    v_mfma_f32_16x16x32_bf16 v[84:87], v[88:91], v[216:219], v[84:87]
    s_waitcnt lgkmcnt(10)
    v_mfma_f32_4x4x4_16b_bf16 v[68:71], v[220:221], v[220:221], v[68:71]
    v_mfma_f32_4x4x4_16b_bf16 v[72:75], v[222:223], v[222:223], v[72:75]
    ds_read_b64_tr_b16 v[240:241], v6 offset:28672
    ds_read_b64_tr_b16 v[242:243], v6 offset:28928
    ds_read_b64_tr_b16 v[244:245], v6 offset:29696
    ds_read_b64_tr_b16 v[246:247], v6 offset:29952
    v_mfma_f32_16x16x32_bf16 v[84:87], v[88:91], v[220:223], v[84:87]
    s_waitcnt lgkmcnt(12)
    v_mfma_f32_32x32x16_bf16 v[36:51], v[224:227], v[208:211], v[36:51]
    ds_read_b64_tr_b16 v[248:249], v6 offset:30720
    ds_read_b64_tr_b16 v[250:251], v6 offset:30976
    ds_read_b64_tr_b16 v[252:253], v6 offset:31744
    ds_read_b64_tr_b16 v[254:255], v6 offset:32000
    s_waitcnt lgkmcnt(8)
    v_add_f32 v28, v28, v29
    v_add_f32 v30, v30, v31
    v_add_f32 v32, v32, v33
    v_add_f32 v34, v34, v35
    v_mfma_f32_32x32x16_bf16 v[52:67], v[208:211], v[228:231], v[52:67]
    v_add_f32 v28, v28, v30
    v_add_f32 v32, v32, v34
    v_cvt_pk_bf16_f32 v29, v28, v28
    v_cvt_pk_bf16_f32 v33, v32, v32
    v_and_b32 v29, 0xffff0000, v29
    v_and_b32 v33, 0xffff0000, v33
    v_mfma_f32_32x32x16_bf16 v[36:51], v[232:235], v[212:215], v[36:51]
    v_sub_f32 v28, v28, v29
    v_sub_f32 v32, v32, v33
    v_cvt_pk_bf16_f32 v12, v29, v28
    v_cvt_pk_bf16_f32 v16, v33, v32
    v_mov_b32 v13, v12
    v_mov_b32 v17, v16
    v_mfma_f32_32x32x16_bf16 v[52:67], v[212:215], v[236:239], v[52:67]
    v_cndmask_b32 v68, v68, v69, s[46:47]
    v_cndmask_b32 v69, v70, v71, s[46:47]
    v_cndmask_b32 v70, v72, v73, s[46:47]
    v_cndmask_b32 v71, v74, v75, s[46:47]
    s_waitcnt lgkmcnt(6)
    v_mfma_f32_32x32x16_bf16 v[36:51], v[240:243], v[216:219], v[36:51]
    v_cndmask_b32 v68, v68, v69, s[48:49]
    v_cndmask_b32 v69, v70, v71, s[48:49]
    v_add_f32 v68, v68, v69
    s_waitcnt lgkmcnt(4)
    v_mfma_f32_32x32x16_bf16 v[52:67], v[216:219], v[244:247], v[52:67]
    v_mov_b32 v69, v68
    v_mul_f32 v28, v84, v11
    v_mul_f32 v84, 0x3b000000, v84
    v_permlane32_swap_b32 v68, v69
    v_cvt_pk_bf16_f32 v92, v28, v28
    v_add_f32 v68, v68, v69
    s_waitcnt lgkmcnt(2)
    v_mfma_f32_32x32x16_bf16 v[36:51], v[248:251], v[220:223], v[36:51]
    v_lshlrev_b32 v29, 16, v92
    v_mul_f32 v68, 0x3b000000, v68
    v_sub_f32 v28, v28, v29
    v_fma_f32 v68, -v84, v84, v68
    v_cvt_pk_bf16_f32 v93, v28, v28
    v_max_f32 v68, 0, v68
    s_waitcnt lgkmcnt(0)
    v_mfma_f32_32x32x16_bf16 v[52:67], v[220:223], v[252:255], v[52:67]
    v_add_f32 v68, 0x3727c5ac, v68
    v_rsq_f32 v86, v68
    v_mfma_f32_32x32x16_bf16 v[36:51], v[12:15], v[92:95], v[36:51]
    v_mov_b32 v32, v86
    v_mul_f32 v87, 0x3eb8aa3b, v86
    v_cvt_pk_bf16_f32 v33, v32, v32
    v_and_b32 v33, 0xffff0000, v33
    v_sub_f32 v32, v32, v33
    v_cvt_pk_bf16_f32 v20, v33, v32
    v_mfma_f32_32x32x16_bf16 v[52:67], v[92:95], v[16:19], v[52:67]
    s_nop 0
    v_mfma_f32_32x32x16_bf16 v[68:83], v[20:23], v[24:27], 0
    s_nop 2
    v_mul_f32 v36, v36, v86
    v_mul_f32 v37, v37, v86
    v_mul_f32 v38, v38, v86
    v_mul_f32 v39, v39, v86
    v_mul_f32 v40, v40, v86
    v_mul_f32 v41, v41, v86
    v_mul_f32 v42, v42, v86
    v_mul_f32 v43, v43, v86
    v_mul_f32 v44, v44, v86
    v_mul_f32 v45, v45, v86
    v_mul_f32 v46, v46, v86
    v_mul_f32 v47, v47, v86
    v_mul_f32 v48, v48, v86
    v_mul_f32 v49, v49, v86
    v_mul_f32 v50, v50, v86
    v_mul_f32 v51, v51, v86
    v_cvt_pk_bf16_f32 v36, v36, v37
    v_cvt_pk_bf16_f32 v37, v38, v39
    v_cvt_pk_bf16_f32 v38, v40, v41
    v_cvt_pk_bf16_f32 v39, v42, v43
    buffer_store_dwordx4 v[36:39], v8, s[4:7], s56 offen offset:0 sc1
    v_cvt_pk_bf16_f32 v40, v44, v45
    v_cvt_pk_bf16_f32 v41, v46, v47
    v_cvt_pk_bf16_f32 v42, v48, v49
    v_cvt_pk_bf16_f32 v43, v50, v51
    buffer_store_dwordx4 v[40:43], v8, s[4:7], s56 offen offset:2048 sc1
    v_mul_f32 v52, v52, v68
    v_mul_f32 v53, v53, v69
    v_mul_f32 v54, v54, v70
    v_mul_f32 v55, v55, v71
    v_mul_f32 v56, v56, v72
    v_mul_f32 v57, v57, v73
    v_mul_f32 v58, v58, v74
    v_mul_f32 v59, v59, v75
    v_mul_f32 v60, v60, v76
    v_mul_f32 v61, v61, v77
    v_mul_f32 v62, v62, v78
    v_mul_f32 v63, v63, v79
    v_mul_f32 v64, v64, v80
    v_mul_f32 v65, v65, v81
    v_mul_f32 v66, v66, v82
    v_mul_f32 v67, v67, v83
    v_cvt_pk_bf16_f32 v52, v52, v53
    v_cvt_pk_bf16_f32 v53, v54, v55
    v_cvt_pk_bf16_f32 v54, v56, v57
    v_cvt_pk_bf16_f32 v55, v58, v59
    buffer_store_dwordx4 v[52:55], v9, s[4:7], s56 offen offset:1024 sc1
    v_cvt_pk_bf16_f32 v56, v60, v61
    v_cvt_pk_bf16_f32 v57, v62, v63
    v_cvt_pk_bf16_f32 v58, v64, v65
    v_cvt_pk_bf16_f32 v59, v66, v67
    buffer_store_dwordx4 v[56:59], v9, s[4:7], s56 offen offset:1536 sc1
    ds_write_b128 v8, v[36:39] offset:0
    ds_write_b128 v9, v[52:55] offset:1024
    ds_write_b128 v8, v[40:43] offset:2048
    ds_write_b128 v9, v[56:59] offset:1536
    v_add_u32 v6, 57344, v6
    s_waitcnt lgkmcnt(0)
    s_barrier
    ds_read_b64_tr_b16 v[224:225], v6 offset:0
    ds_read_b64_tr_b16 v[226:227], v6 offset:256
    ds_read_b64_tr_b16 v[228:229], v6 offset:1024
    ds_read_b64_tr_b16 v[230:231], v6 offset:1280
    ds_read_b64_tr_b16 v[232:233], v6 offset:2048
    ds_read_b64_tr_b16 v[234:235], v6 offset:2304
    s_waitcnt lgkmcnt(4)
    v_mfma_f32_32x32x16_bf16 v[52:67], v[224:227], v[96:99], 0
    ds_read_b64_tr_b16 v[236:237], v6 offset:3072
    ds_read_b64_tr_b16 v[238:239], v6 offset:3328
    s_lshr_b32 s46, s40, 2
    s_lshl_b32 s46, s46, 11
    v_lshlrev_b32 v2, 4, v1
    v_add_u32 v4, s46, v2
    v_and_b32 v5, 15, v1
    s_waitcnt lgkmcnt(4)
    v_mfma_f32_32x32x16_bf16 v[52:67], v[228:231], v[100:103], v[52:67]
    ds_read_b64_tr_b16 v[224:225], v6 offset:4096
    ds_read_b64_tr_b16 v[226:227], v6 offset:4352
    v_lshlrev_b32 v5, 4, v5
    v_lshrrev_b32 v7, 5, v1
    v_lshl_add_u32 v5, v7, 8, v5
    s_waitcnt lgkmcnt(4)
    v_mfma_f32_32x32x16_bf16 v[52:67], v[232:235], v[104:107], v[52:67]
    ds_read_b64_tr_b16 v[228:229], v6 offset:5120
    ds_read_b64_tr_b16 v[230:231], v6 offset:5376
    v_add_u32 v5, s46, v5
    v_and_b32 v85, 31, v1
    v_lshlrev_b32 v85, 10, v85
    s_waitcnt lgkmcnt(4)
    v_mfma_f32_32x32x16_bf16 v[52:67], v[236:239], v[108:111], v[52:67]
    ds_read_b64_tr_b16 v[232:233], v6 offset:6144
    ds_read_b64_tr_b16 v[234:235], v6 offset:6400
    v_lshl_add_u32 v85, v7, 4, v85
    s_lshl_b32 s46, s43, 2
    s_lshr_b32 s47, s44, 3
    s_lshl_b32 s47, s47, 1
    s_add_u32 s46, s46, s47
    s_and_b32 s47, s40, 1
    s_add_u32 s46, s46, s47
    s_waitcnt lgkmcnt(4)
    v_mfma_f32_32x32x16_bf16 v[52:67], v[224:227], v[112:115], v[52:67]
    ds_read_b64_tr_b16 v[236:237], v6 offset:7168
    ds_read_b64_tr_b16 v[238:239], v6 offset:7424
    s_lshl_b32 s46, s46, 15
    s_and_b32 s47, s44, 7
    s_lshl_b32 s47, s47, 7
    s_add_u32 s46, s46, s47
    s_lshr_b32 s47, s40, 1
    s_lshl_b32 s47, s47, 6
    s_add_u32 s57, s46, s47
    v_add_u32 v85, s57, v85
    s_waitcnt lgkmcnt(4)
    v_mfma_f32_32x32x16_bf16 v[52:67], v[228:231], v[116:119], v[52:67]
    ds_read_b64_tr_b16 v[224:225], v6 offset:8192
    ds_read_b64_tr_b16 v[226:227], v6 offset:8448
    s_lshl_b32 s46, s44, 11
    s_lshl_b32 s47, s43, 7
    s_add_u32 s46, s46, s47
    s_lshl_b32 s47, s40, 2
    s_add_u32 s46, s46, s47
    s_add_u32 s56, s46, 15728640
    s_lshl_b32 s46, s40, 10
    s_add_u32 s46, s46, 155648
    v_add_u32 v88, s46, v2
    s_waitcnt lgkmcnt(4)
    v_mfma_f32_32x32x16_bf16 v[52:67], v[232:235], v[120:123], v[52:67]
    ds_read_b64_tr_b16 v[228:229], v6 offset:9216
    ds_read_b64_tr_b16 v[230:231], v6 offset:9472
    s_lshl_b32 s46, s40, 2
    s_add_u32 s46, s46, 161792
    v_mov_b32 v91, s46
    v_mov_b32 v84, 0xdddddddd
    v_mov_b32 v7, 0x3f803f80
    s_waitcnt lgkmcnt(4)
    v_mfma_f32_32x32x16_bf16 v[52:67], v[236:239], v[124:127], v[52:67]
    ds_read_b64_tr_b16 v[232:233], v6 offset:10240
    ds_read_b64_tr_b16 v[234:235], v6 offset:10496
    s_mov_b32 s46, 0x00110000
    s_mov_b32 s47, 0x00110000
    v_cndmask_b32 v20, 0, v7, s[46:47]
    v_cndmask_b32 v21, 0, v7, s[46:47]
    v_mov_b64 v[68:69], 0
    s_waitcnt lgkmcnt(4)
    v_mfma_f32_32x32x16_bf16 v[52:67], v[224:227], v[128:131], v[52:67]
    ds_read_b64_tr_b16 v[236:237], v6 offset:11264
    ds_read_b64_tr_b16 v[238:239], v6 offset:11520
    v_mov_b64 v[70:71], 0
    v_mov_b64 v[72:73], 0
    v_mov_b64 v[74:75], 0
    s_waitcnt lgkmcnt(4)
    v_mfma_f32_32x32x16_bf16 v[52:67], v[228:231], v[132:135], v[52:67]
    ds_read_b64_tr_b16 v[224:225], v6 offset:12288
    ds_read_b64_tr_b16 v[226:227], v6 offset:12544
    v_mov_b64 v[76:77], 0
    v_mov_b64 v[78:79], 0
    v_mov_b64 v[80:81], 0
    s_waitcnt lgkmcnt(4)
    v_mfma_f32_32x32x16_bf16 v[52:67], v[232:235], v[136:139], v[52:67]
    ds_read_b64_tr_b16 v[228:229], v6 offset:13312
    ds_read_b64_tr_b16 v[230:231], v6 offset:13568
    v_mov_b64 v[82:83], 0
    v_mov_b64 v[22:23], v[20:21]
    v_mov_b64 v[24:25], v[20:21]
    s_waitcnt lgkmcnt(4)
    v_mfma_f32_32x32x16_bf16 v[52:67], v[236:239], v[140:143], v[52:67]
    ds_read_b64_tr_b16 v[232:233], v6 offset:14336
    ds_read_b64_tr_b16 v[234:235], v6 offset:14592
    v_mov_b64 v[26:27], v[20:21]
    v_mov_b64 v[28:29], v[20:21]
    v_mov_b64 v[30:31], v[20:21]
    s_waitcnt lgkmcnt(4)
    v_mfma_f32_32x32x16_bf16 v[52:67], v[224:227], v[144:147], v[52:67]
    ds_read_b64_tr_b16 v[236:237], v6 offset:15360
    ds_read_b64_tr_b16 v[238:239], v6 offset:15616
    v_mov_b64 v[32:33], v[20:21]
    v_mov_b64 v[34:35], v[20:21]
    s_mov_b32 s54, 0xffff
    s_mov_b32 s55, 0xffff
    v_bfe_u32 v3, v1, 2, 3
    s_waitcnt lgkmcnt(4)
    v_mfma_f32_32x32x16_bf16 v[52:67], v[228:231], v[148:151], v[52:67]
    s_barrier
    ds_read_b128 v[252:255], v10 offset:1024
    ds_read_b64_tr_b16 v[224:225], v6 offset:16384
    ds_read_b64_tr_b16 v[226:227], v6 offset:16640
    v_lshlrev_b32 v3, 10, v3
    v_and_b32 v7, 3, v1
    v_lshl_add_u32 v3, v7, 4, v3
    s_waitcnt lgkmcnt(5)
    v_mfma_f32_32x32x16_bf16 v[52:67], v[232:235], v[152:155], v[52:67]
    ds_read_b64_tr_b16 v[228:229], v6 offset:17408
    ds_read_b64_tr_b16 v[230:231], v6 offset:17664
    s_waitcnt vmcnt(0)
    v_mov_b32 v89, 0
    v_mov_b32 v90, 1
    s_mov_b64 exec, 1
    buffer_store_dword v90, v89, s[4:7], s56 offen sc1
    s_mov_b64 exec, -1
    v_lshrrev_b32 v7, 5, v1
    v_lshl_add_u32 v3, v7, 6, v3
    s_lshl_b32 s46, s40, 4
    s_add_u32 s46, s46, 0
    v_lshrrev_b32 v7, 2, v1
    s_waitcnt lgkmcnt(5)
    v_mfma_f32_32x32x16_bf16 v[52:67], v[236:239], v[156:159], v[52:67]
    ds_read_b64_tr_b16 v[232:233], v6 offset:18432
    ds_read_b64_tr_b16 v[234:235], v6 offset:18688
    v_add_u32 v7, s46, v7
    v_mul_u32_u24 v248, 171, v7
    v_lshrrev_b32 v248, 9, v248
    s_waitcnt lgkmcnt(4)
    v_mfma_f32_32x32x16_bf16 v[52:67], v[224:227], v[160:163], v[52:67]
    ds_read_b64_tr_b16 v[236:237], v6 offset:19456
    ds_read_b64_tr_b16 v[238:239], v6 offset:19712
    v_mul_u32_u24 v251, 3, v248
    v_sub_u32 v7, v7, v251
    v_mul_u32_u24 v248, 2752, v248
    s_waitcnt lgkmcnt(4)
    v_mfma_f32_32x32x16_bf16 v[52:67], v[228:231], v[164:167], v[52:67]
    ds_read_b64_tr_b16 v[224:225], v6 offset:20480
    ds_read_b64_tr_b16 v[226:227], v6 offset:20736
    v_lshl_add_u32 v248, v7, 6, v248
    v_and_b32 v7, 3, v1
    v_lshl_add_u32 v248, v7, 4, v248
    s_waitcnt lgkmcnt(4)
    v_mfma_f32_32x32x16_bf16 v[52:67], v[232:235], v[168:171], v[52:67]
    ds_read_b64_tr_b16 v[228:229], v6 offset:21504
    ds_read_b64_tr_b16 v[230:231], v6 offset:21760
    s_lshl_b32 s46, s40, 4
    s_add_u32 s46, s46, 128
    v_lshrrev_b32 v7, 2, v1
    v_add_u32 v7, s46, v7
    v_mul_u32_u24 v249, 171, v7
    s_waitcnt lgkmcnt(4)
    v_mfma_f32_32x32x16_bf16 v[52:67], v[236:239], v[172:175], v[52:67]
    ds_read_b64_tr_b16 v[232:233], v6 offset:22528
    ds_read_b64_tr_b16 v[234:235], v6 offset:22784
    v_lshrrev_b32 v249, 9, v249
    v_mul_u32_u24 v251, 3, v249
    v_sub_u32 v7, v7, v251
    s_waitcnt lgkmcnt(4)
    v_mfma_f32_32x32x16_bf16 v[52:67], v[224:227], v[176:179], v[52:67]
    ds_read_b64_tr_b16 v[236:237], v6 offset:23552
    ds_read_b64_tr_b16 v[238:239], v6 offset:23808
    v_mul_u32_u24 v249, 2752, v249
    v_lshl_add_u32 v249, v7, 6, v249
    v_and_b32 v7, 3, v1
    s_waitcnt lgkmcnt(4)
    v_mfma_f32_32x32x16_bf16 v[52:67], v[228:231], v[180:183], v[52:67]
    ds_read_b64_tr_b16 v[224:225], v6 offset:24576
    ds_read_b64_tr_b16 v[226:227], v6 offset:24832
    v_lshl_add_u32 v249, v7, 4, v249
    s_lshl_b32 s46, s40, 4
    s_add_u32 s46, s46, 256
    v_lshrrev_b32 v7, 2, v1
    v_add_u32 v7, s46, v7
    s_waitcnt lgkmcnt(4)
    v_mfma_f32_32x32x16_bf16 v[52:67], v[232:235], v[184:187], v[52:67]
    ds_read_b64_tr_b16 v[228:229], v6 offset:25600
    ds_read_b64_tr_b16 v[230:231], v6 offset:25856
    v_mul_u32_u24 v250, 171, v7
    v_lshrrev_b32 v250, 9, v250
    v_mul_u32_u24 v251, 3, v250
    s_waitcnt lgkmcnt(4)
    v_mfma_f32_32x32x16_bf16 v[52:67], v[236:239], v[188:191], v[52:67]
    ds_read_b64_tr_b16 v[232:233], v6 offset:26624
    ds_read_b64_tr_b16 v[234:235], v6 offset:26880
    v_sub_u32 v7, v7, v251
    v_mul_u32_u24 v250, 2752, v250
    v_lshl_add_u32 v250, v7, 6, v250
    s_waitcnt lgkmcnt(4)
    v_mfma_f32_32x32x16_bf16 v[52:67], v[224:227], v[192:195], v[52:67]
    ds_read_b64_tr_b16 v[236:237], v6 offset:27648
    ds_read_b64_tr_b16 v[238:239], v6 offset:27904
    v_and_b32 v7, 3, v1
    v_lshl_add_u32 v250, v7, 4, v250
    s_mul_i32 s48, s44, 192
    s_lshl_b32 s37, s40, 10
    s_add_u32 s50, s37, 114688
    s_waitcnt lgkmcnt(4)
    v_mfma_f32_32x32x16_bf16 v[52:67], v[228:231], v[196:199], v[52:67]
    ds_read_b64_tr_b16 v[224:225], v6 offset:28672
    ds_read_b64_tr_b16 v[226:227], v6 offset:28928
    s_add_u32 s37, s37, 49152
    s_lshl_b32 s49, s40, 13
    s_and_b32 s46, s44, 7
    s_lshl_b32 s46, s46, 7
    s_add_u32 s49, s49, s46
    s_lshl_b32 s53, s40, 11
    s_lshl_b32 s52, s44, 18
    s_add_u32 s52, s52, s53
    s_add_u32 s51, s43, 2
    s_waitcnt lgkmcnt(4)
    v_mfma_f32_32x32x16_bf16 v[52:67], v[232:235], v[200:203], v[52:67]
    ds_read_b64_tr_b16 v[228:229], v6 offset:29696
    ds_read_b64_tr_b16 v[230:231], v6 offset:29952
    s_and_b32 s51, s51, 14
    s_lshl_b32 s51, s51, 14
    s_and_b32 s46, s2, 0xf8
    s_add_u32 s46, s46, s40
    s_mul_i32 s46, s46, 43
    v_min_u32 v251, 42, v1
    v_add_u32 v251, s46, v251
    s_waitcnt lgkmcnt(4)
    v_mfma_f32_32x32x16_bf16 v[52:67], v[236:239], v[204:207], v[52:67]
    ds_read_b64_tr_b16 v[232:233], v6 offset:30720
    ds_read_b64_tr_b16 v[234:235], v6 offset:30976
    v_lshlrev_b32 v251, 7, v251
    v_add_f32 v252, v252, v253
    v_add_f32 v254, v254, v255
    s_waitcnt lgkmcnt(4)
    v_mfma_f32_32x32x16_bf16 v[52:67], v[224:227], v[208:211], v[52:67]
    ds_read_b64_tr_b16 v[236:237], v6 offset:31744
    ds_read_b64_tr_b16 v[238:239], v6 offset:32000
    v_add_f32 v252, v252, v254
    v_cvt_pk_bf16_f32 v253, v252, v252
    v_and_b32 v253, 0xffff0000, v253
    s_waitcnt lgkmcnt(4)
    v_mfma_f32_32x32x16_bf16 v[52:67], v[228:231], v[212:215], v[52:67]
    v_sub_f32 v252, v252, v253
    v_cvt_pk_bf16_f32 v16, v253, v252
    v_mov_b32 v17, v16
    s_waitcnt lgkmcnt(2)
    v_mfma_f32_32x32x16_bf16 v[52:67], v[232:235], v[216:219], v[52:67]
    s_waitcnt lgkmcnt(0)
    v_mfma_f32_32x32x16_bf16 v[52:67], v[236:239], v[220:223], v[52:67]
    v_mfma_f32_32x32x16_bf16 v[52:67], v[16:19], v[92:95], v[52:67]
    v_mov_b32 v90, 1
    s_nop 10
    v_mul_f32 v60, v60, v87
    v_mul_f32 v61, v61, v87
    v_mul_f32 v62, v62, v87
    v_mul_f32 v63, v63, v87
    v_mul_f32 v64, v64, v87
    v_mul_f32 v65, v65, v87
    v_mul_f32 v66, v66, v87
    v_mul_f32 v67, v67, v87
    v_cvt_pk_bf16_f32 v60, v60, v61
    v_cvt_pk_bf16_f32 v61, v62, v63
    v_cvt_pk_bf16_f32 v62, v64, v65
    v_cvt_pk_bf16_f32 v63, v66, v67
    ds_write_b128 v88, v[60:63]
    ds_write_b32 v91, v90
    v_mul_f32 v52, v52, v87
    v_mul_f32 v53, v53, v87
    v_mul_f32 v54, v54, v87
    v_mul_f32 v55, v55, v87
    v_mul_f32 v56, v56, v87
    v_mul_f32 v57, v57, v87
    v_mul_f32 v58, v58, v87
    v_mul_f32 v59, v59, v87
    v_cvt_pk_bf16_f32 v8, v52, v53
    v_cvt_pk_bf16_f32 v9, v54, v55
    v_cvt_pk_bf16_f32 v10, v56, v57
    v_cvt_pk_bf16_f32 v11, v58, v59
.Lb0:
    ds_read_b128 v[12:15], v4 offset:0
    ds_read_b128 v[16:19], v4 offset:4096
    s_mov_b64 exec, s[54:55]
    ds_read_b128 v[20:23], v5 offset:1024
    ds_read_b128 v[24:27], v5 offset:1536
    s_mov_b64 exec, -1
.Lb0q:
    s_waitcnt lgkmcnt(3)
    v_mfma_f32_32x32x16_bf16 v[36:51], v[12:15], v[8:11], 0
    s_nop 10
    s_setprio 3
    v_exp_f32 v36, v36
    v_exp_f32 v37, v37
    s_waitcnt lgkmcnt(2)
    v_exp_f32 v38, v38
    v_exp_f32 v39, v39
    v_exp_f32 v40, v40
    v_exp_f32 v41, v41
    v_mfma_f32_32x32x16_bf16 v[52:67], v[16:19], v[8:11], 0
    ds_read_b128 v[12:15], v4 offset:8192
    v_exp_f32 v42, v42
    v_exp_f32 v43, v43
    v_exp_f32 v44, v44
    v_exp_f32 v45, v45
    s_waitcnt lgkmcnt(1)
    v_smfmac_f32_32x32x32_bf16 v[68:83], v[20:23], v[36:43], v84
    v_exp_f32 v46, v46
    v_exp_f32 v47, v47
    s_mov_b64 exec, s[54:55]
    ds_read_b128 v[28:31], v5 offset:5120
    ds_read_b128 v[32:35], v5 offset:5632
    s_mov_b64 exec, -1
    v_exp_f32 v48, v48
    v_exp_f32 v49, v49
    v_exp_f32 v50, v50
    v_exp_f32 v51, v51
    s_setprio 2
    v_exp_f32 v52, v52
    v_exp_f32 v53, v53
    v_smfmac_f32_32x32x32_bf16 v[68:83], v[24:27], v[44:51], v84
    s_waitcnt lgkmcnt(2)
    v_exp_f32 v54, v54
    v_exp_f32 v55, v55
    v_exp_f32 v56, v56
    v_exp_f32 v57, v57
    v_mfma_f32_32x32x16_bf16 v[36:51], v[12:15], v[8:11], 0
    ds_read_b128 v[16:19], v4 offset:12288
    s_cmp_lt_u32 s40, 4
    s_cbranch_scc1 .Lb_gl0
    s_add_u32 m0, s36, 32768
    s_nop 0
    buffer_load_dwordx4 v2, s[4:7], s39 offen sc1 lds
    buffer_load_dwordx4 v2, s[4:7], s39 offen offset:1024 sc1 lds
.Lb_gl0:
    v_exp_f32 v58, v58
    v_exp_f32 v59, v59
    v_exp_f32 v60, v60
    v_exp_f32 v61, v61
    s_waitcnt lgkmcnt(1)
    v_smfmac_f32_32x32x32_bf16 v[68:83], v[28:31], v[52:59], v84
    v_exp_f32 v62, v62
    v_exp_f32 v63, v63
    s_mov_b64 exec, s[54:55]
    ds_read_b128 v[20:23], v5 offset:9216
    ds_read_b128 v[24:27], v5 offset:9728
    s_mov_b64 exec, -1
    v_exp_f32 v64, v64
    v_exp_f32 v65, v65
    v_exp_f32 v66, v66
    v_exp_f32 v67, v67
    s_setprio 1
    v_exp_f32 v36, v36
    v_exp_f32 v37, v37
    v_smfmac_f32_32x32x32_bf16 v[68:83], v[32:35], v[60:67], v84
    s_waitcnt lgkmcnt(2)
    v_exp_f32 v38, v38
    v_exp_f32 v39, v39
    v_exp_f32 v40, v40
    v_exp_f32 v41, v41
    v_mfma_f32_32x32x16_bf16 v[52:67], v[16:19], v[8:11], 0
    s_cmp_lt_u32 s40, 4
    s_cbranch_scc1 .Lb_gl1
    s_add_u32 m0, s36, 32768
    s_nop 0
    buffer_load_dwordx4 v2, s[4:7], s39 offen offset:2048 sc1 lds
    buffer_load_dwordx4 v2, s[4:7], s39 offen offset:3072 sc1 lds
    s_mov_b32 s39, s56
.Lb_gl1:
    s_cmp_lt_u32 s40, 4
    s_cbranch_scc1 .Lb_ns
    buffer_load_dword v90, v6, s[4:7], s39 offen sc1
.Lb_ns:
    v_exp_f32 v42, v42
    v_exp_f32 v43, v43
    v_exp_f32 v44, v44
    v_exp_f32 v45, v45
    s_waitcnt lgkmcnt(0)
    v_smfmac_f32_32x32x32_bf16 v[68:83], v[20:23], v[36:43], v84
    v_exp_f32 v46, v46
    v_exp_f32 v47, v47
    s_mov_b64 exec, s[54:55]
    ds_read_b128 v[28:31], v5 offset:13312
    ds_read_b128 v[32:35], v5 offset:13824
    s_mov_b64 exec, -1
    v_exp_f32 v48, v48
    v_exp_f32 v49, v49
    v_exp_f32 v50, v50
    v_exp_f32 v51, v51
    s_setprio 0
    v_exp_f32 v52, v52
    v_exp_f32 v53, v53
    v_smfmac_f32_32x32x32_bf16 v[68:83], v[24:27], v[44:51], v84
    v_exp_f32 v54, v54
    v_exp_f32 v55, v55
    v_exp_f32 v56, v56
    v_exp_f32 v57, v57
    v_exp_f32 v58, v58
    v_exp_f32 v59, v59
    v_exp_f32 v60, v60
    v_exp_f32 v61, v61
    s_waitcnt lgkmcnt(0)
    v_smfmac_f32_32x32x32_bf16 v[68:83], v[28:31], v[52:59], v84
    v_exp_f32 v62, v62
    v_exp_f32 v63, v63
    v_exp_f32 v64, v64
    v_exp_f32 v65, v65
    v_exp_f32 v66, v66
    v_exp_f32 v67, v67
    s_nop 1
    v_smfmac_f32_32x32x32_bf16 v[68:83], v[32:35], v[60:67], v84
    s_cmp_lt_u32 s40, 4
    s_cbranch_scc1 .Lb_p2
    s_waitcnt vmcnt(5)
.Lb_p2:
    v_mov_b32 v60, 0
    v_mov_b32 v61, 0
    v_mov_b32 v62, 0
    v_mov_b32 v63, 0
    v_mov_b32 v64, 0
    v_mov_b32 v65, 0
    v_mov_b32 v66, 0
    v_mov_b32 v67, 0
    s_mov_b32 s57, 0
    s_barrier
    ds_read_b128 v[12:15], v4 offset:16384
    ds_read_b128 v[16:19], v4 offset:20480
    s_mov_b64 exec, s[54:55]
    ds_read_b128 v[20:23], v5 offset:17408
    ds_read_b128 v[24:27], v5 offset:17920
    s_mov_b64 exec, -1
    s_waitcnt lgkmcnt(3)
    v_mfma_f32_32x32x16_bf16 v[36:51], v[12:15], v[8:11], 0
    s_nop 10
.Lb_loop1:
    s_setprio 2
    v_exp_f32 v36, v36
    v_exp_f32 v37, v37
    v_smfmac_f32_32x32x32_bf16 v[68:83], v[32:35], v[60:67], v84
    s_waitcnt lgkmcnt(2)
    v_exp_f32 v38, v38
    v_exp_f32 v39, v39
    v_exp_f32 v40, v40
    v_exp_f32 v41, v41
    v_mfma_f32_32x32x16_bf16 v[52:67], v[16:19], v[8:11], 0
    v_exp_f32 v42, v42
    v_exp_f32 v43, v43
    v_exp_f32 v44, v44
    v_exp_f32 v45, v45
    s_waitcnt lgkmcnt(0)
    v_smfmac_f32_32x32x32_bf16 v[68:83], v[20:23], v[36:43], v84
    ds_read_b128 v[12:15], v4 offset:24576
    v_exp_f32 v46, v46
    v_exp_f32 v47, v47
    s_mov_b64 exec, s[54:55]
    ds_read_b128 v[28:31], v5 offset:21504
    ds_read_b128 v[32:35], v5 offset:22016
    s_mov_b64 exec, -1
    v_exp_f32 v48, v48
    v_exp_f32 v49, v49
    v_exp_f32 v50, v50
    v_exp_f32 v51, v51
    s_setprio 1
    v_exp_f32 v52, v52
    v_exp_f32 v53, v53
    v_smfmac_f32_32x32x32_bf16 v[68:83], v[24:27], v[44:51], v84
    s_waitcnt lgkmcnt(2)
    v_exp_f32 v54, v54
    v_exp_f32 v55, v55
    v_exp_f32 v56, v56
    v_exp_f32 v57, v57
    v_mfma_f32_32x32x16_bf16 v[36:51], v[12:15], v[8:11], 0
    v_exp_f32 v58, v58
    v_exp_f32 v59, v59
    v_exp_f32 v60, v60
    v_exp_f32 v61, v61
    s_waitcnt lgkmcnt(0)
    v_smfmac_f32_32x32x32_bf16 v[68:83], v[28:31], v[52:59], v84
    ds_read_b128 v[16:19], v4 offset:28672
    v_exp_f32 v62, v62
    v_exp_f32 v63, v63
    s_mov_b64 exec, s[54:55]
    ds_read_b128 v[20:23], v5 offset:25600
    ds_read_b128 v[24:27], v5 offset:26112
    s_mov_b64 exec, -1
    v_exp_f32 v64, v64
    v_exp_f32 v65, v65
    v_exp_f32 v66, v66
    v_exp_f32 v67, v67
    s_mov_b32 m0, s50
    s_add_u32 s50, s50, 8192
    buffer_load_dwordx4 v248, s[24:27], s48 offen lds
    s_setprio 0
    v_exp_f32 v36, v36
    v_exp_f32 v37, v37
    v_smfmac_f32_32x32x32_bf16 v[68:83], v[32:35], v[60:67], v84
    s_waitcnt lgkmcnt(2)
    v_exp_f32 v38, v38
    v_exp_f32 v39, v39
    v_exp_f32 v40, v40
    v_exp_f32 v41, v41
    v_mfma_f32_32x32x16_bf16 v[52:67], v[16:19], v[8:11], 0
    v_exp_f32 v42, v42
    v_exp_f32 v43, v43
    v_exp_f32 v44, v44
    v_exp_f32 v45, v45
    s_waitcnt lgkmcnt(0)
    v_smfmac_f32_32x32x32_bf16 v[68:83], v[20:23], v[36:43], v84
    s_waitcnt vmcnt(1)
    v_cmp_ne_u32 vcc, 0, v90
    s_cmp_eq_u64 vcc, -1
    s_cbranch_scc0 .Lb_late
.Lb_seen:
    s_barrier
    ds_read_b128 v[12:15], v4 offset:32768
    v_exp_f32 v46, v46
    v_exp_f32 v47, v47
    s_mov_b64 exec, s[54:55]
    ds_read_b128 v[28:31], v5 offset:29696
    ds_read_b128 v[32:35], v5 offset:30208
    s_mov_b64 exec, -1
    v_exp_f32 v48, v48
    v_exp_f32 v49, v49
    v_exp_f32 v50, v50
    v_exp_f32 v51, v51
    s_add_u32 s51, s51, 16384
    s_and_b32 s51, s51, 0x3ffff
    s_add_u32 s56, s51, s52
    s_add_u32 m0, s53, 0
    s_nop 0
    buffer_load_dwordx4 v2, s[4:7], s56 offen sc1 lds
    s_setprio 3
    v_exp_f32 v52, v52
    v_exp_f32 v53, v53
    v_smfmac_f32_32x32x32_bf16 v[68:83], v[24:27], v[44:51], v84
    s_waitcnt lgkmcnt(2)
    v_exp_f32 v54, v54
    v_exp_f32 v55, v55
    v_exp_f32 v56, v56
    v_exp_f32 v57, v57
    v_mfma_f32_32x32x16_bf16 v[36:51], v[12:15], v[8:11], 0
    v_exp_f32 v58, v58
    v_exp_f32 v59, v59
    v_exp_f32 v60, v60
    v_exp_f32 v61, v61
    s_waitcnt lgkmcnt(0)
    v_smfmac_f32_32x32x32_bf16 v[68:83], v[28:31], v[52:59], v84
    ds_read_b128 v[16:19], v4 offset:36864
    v_exp_f32 v62, v62
    v_exp_f32 v63, v63
    s_mov_b64 exec, s[54:55]
    ds_read_b128 v[20:23], v5 offset:33792
    ds_read_b128 v[24:27], v5 offset:34304
    s_mov_b64 exec, -1
    v_exp_f32 v64, v64
    v_exp_f32 v65, v65
    v_exp_f32 v66, v66
    v_exp_f32 v67, v67
    s_add_u32 m0, s53, 0
    s_nop 0
    buffer_load_dwordx4 v2, s[4:7], s56 offen offset:1024 sc1 lds
    s_setprio 2
    v_exp_f32 v36, v36
    v_exp_f32 v37, v37
    v_smfmac_f32_32x32x32_bf16 v[68:83], v[32:35], v[60:67], v84
    s_waitcnt lgkmcnt(2)
    v_exp_f32 v38, v38
    v_exp_f32 v39, v39
    v_exp_f32 v40, v40
    v_exp_f32 v41, v41
    v_mfma_f32_32x32x16_bf16 v[52:67], v[16:19], v[8:11], 0
    v_exp_f32 v42, v42
    v_exp_f32 v43, v43
    v_exp_f32 v44, v44
    v_exp_f32 v45, v45
    s_waitcnt lgkmcnt(0)
    v_smfmac_f32_32x32x32_bf16 v[68:83], v[20:23], v[36:43], v84
    ds_read_b128 v[12:15], v4 offset:40960
    v_exp_f32 v46, v46
    v_exp_f32 v47, v47
    s_mov_b64 exec, s[54:55]
    ds_read_b128 v[28:31], v5 offset:37888
    ds_read_b128 v[32:35], v5 offset:38400
    s_mov_b64 exec, -1
    v_exp_f32 v48, v48
    v_exp_f32 v49, v49
    v_exp_f32 v50, v50
    v_exp_f32 v51, v51
    s_setprio 1
    v_exp_f32 v52, v52
    v_exp_f32 v53, v53
    v_smfmac_f32_32x32x32_bf16 v[68:83], v[24:27], v[44:51], v84
    s_waitcnt lgkmcnt(2)
    v_exp_f32 v54, v54
    v_exp_f32 v55, v55
    v_exp_f32 v56, v56
    v_exp_f32 v57, v57
    v_mfma_f32_32x32x16_bf16 v[36:51], v[12:15], v[8:11], 0
    v_exp_f32 v58, v58
    v_exp_f32 v59, v59
    v_exp_f32 v60, v60
    v_exp_f32 v61, v61
    s_waitcnt lgkmcnt(0)
    v_smfmac_f32_32x32x32_bf16 v[68:83], v[28:31], v[52:59], v84
    ds_read_b128 v[16:19], v4 offset:45056
    v_exp_f32 v62, v62
    v_exp_f32 v63, v63
    s_mov_b64 exec, s[54:55]
    ds_read_b128 v[20:23], v5 offset:41984
    ds_read_b128 v[24:27], v5 offset:42496
    s_mov_b64 exec, -1
    v_exp_f32 v64, v64
    v_exp_f32 v65, v65
    v_exp_f32 v66, v66
    v_exp_f32 v67, v67
    s_mov_b32 m0, s50
    s_add_u32 s50, s50, 8192
    buffer_load_dwordx4 v249, s[24:27], s48 offen lds
    s_setprio 0
    v_exp_f32 v36, v36
    v_exp_f32 v37, v37
    v_smfmac_f32_32x32x32_bf16 v[68:83], v[32:35], v[60:67], v84
    s_waitcnt lgkmcnt(2)
    v_exp_f32 v38, v38
    v_exp_f32 v39, v39
    v_exp_f32 v40, v40
    v_exp_f32 v41, v41
    v_mfma_f32_32x32x16_bf16 v[52:67], v[16:19], v[8:11], 0
    v_exp_f32 v42, v42
    v_exp_f32 v43, v43
    v_exp_f32 v44, v44
    v_exp_f32 v45, v45
    s_waitcnt lgkmcnt(0)
    v_smfmac_f32_32x32x32_bf16 v[68:83], v[20:23], v[36:43], v84
    s_waitcnt vmcnt(1)
    s_barrier
    ds_read_b128 v[12:15], v4 offset:0
    v_exp_f32 v46, v46
    v_exp_f32 v47, v47
    s_mov_b64 exec, s[54:55]
    ds_read_b128 v[28:31], v5 offset:46080
    ds_read_b128 v[32:35], v5 offset:46592
    s_mov_b64 exec, -1
    v_exp_f32 v48, v48
    v_exp_f32 v49, v49
    v_exp_f32 v50, v50
    v_exp_f32 v51, v51
    s_add_u32 s51, s51, 16384
    s_and_b32 s51, s51, 0x3ffff
    s_add_u32 s56, s51, s52
    s_add_u32 m0, s53, 16384
    s_nop 0
    buffer_load_dwordx4 v2, s[4:7], s56 offen sc1 lds
    s_setprio 3
    v_exp_f32 v52, v52
    v_exp_f32 v53, v53
    v_smfmac_f32_32x32x32_bf16 v[68:83], v[24:27], v[44:51], v84
    s_waitcnt lgkmcnt(2)
    v_exp_f32 v54, v54
    v_exp_f32 v55, v55
    v_exp_f32 v56, v56
    v_exp_f32 v57, v57
    v_mfma_f32_32x32x16_bf16 v[36:51], v[12:15], v[8:11], 0
    v_exp_f32 v58, v58
    v_exp_f32 v59, v59
    v_exp_f32 v60, v60
    v_exp_f32 v61, v61
    s_waitcnt lgkmcnt(0)
    v_smfmac_f32_32x32x32_bf16 v[68:83], v[28:31], v[52:59], v84
    ds_read_b128 v[16:19], v4 offset:4096
    v_exp_f32 v62, v62
    v_exp_f32 v63, v63
    s_mov_b64 exec, s[54:55]
    ds_read_b128 v[20:23], v5 offset:1024
    ds_read_b128 v[24:27], v5 offset:1536
    s_mov_b64 exec, -1
    v_exp_f32 v64, v64
    v_exp_f32 v65, v65
    v_exp_f32 v66, v66
    v_exp_f32 v67, v67
    s_add_u32 m0, s53, 16384
    s_nop 0
    buffer_load_dwordx4 v2, s[4:7], s56 offen offset:1024 sc1 lds
    s_setprio 2
    v_exp_f32 v36, v36
    v_exp_f32 v37, v37
    v_smfmac_f32_32x32x32_bf16 v[68:83], v[32:35], v[60:67], v84
    s_waitcnt lgkmcnt(2)
    v_exp_f32 v38, v38
    v_exp_f32 v39, v39
    v_exp_f32 v40, v40
    v_exp_f32 v41, v41
    v_mfma_f32_32x32x16_bf16 v[52:67], v[16:19], v[8:11], 0
    v_exp_f32 v42, v42
    v_exp_f32 v43, v43
    v_exp_f32 v44, v44
    v_exp_f32 v45, v45
    s_waitcnt lgkmcnt(0)
    v_smfmac_f32_32x32x32_bf16 v[68:83], v[20:23], v[36:43], v84
    ds_read_b128 v[12:15], v4 offset:8192
    v_exp_f32 v46, v46
    v_exp_f32 v47, v47
    s_mov_b64 exec, s[54:55]
    ds_read_b128 v[28:31], v5 offset:5120
    ds_read_b128 v[32:35], v5 offset:5632
    s_mov_b64 exec, -1
    v_exp_f32 v48, v48
    v_exp_f32 v49, v49
    v_exp_f32 v50, v50
    v_exp_f32 v51, v51
    s_cmp_lt_u32 s40, 4
    s_cselect_b64 exec, -1, 1
    buffer_load_dwordx4 v[240:243], v85, s[8:11], 0 offen offset:0
    buffer_load_dwordx4 v[244:247], v85, s[8:11], 0 offen offset:32
    s_mov_b64 exec, -1
    s_setprio 1
    v_exp_f32 v52, v52
    v_exp_f32 v53, v53
    v_smfmac_f32_32x32x32_bf16 v[68:83], v[24:27], v[44:51], v84
    s_waitcnt lgkmcnt(2)
    v_exp_f32 v54, v54
    v_exp_f32 v55, v55
    v_exp_f32 v56, v56
    v_exp_f32 v57, v57
    v_mfma_f32_32x32x16_bf16 v[36:51], v[12:15], v[8:11], 0
    v_exp_f32 v58, v58
    v_exp_f32 v59, v59
    v_exp_f32 v60, v60
    v_exp_f32 v61, v61
    s_waitcnt lgkmcnt(0)
    v_smfmac_f32_32x32x32_bf16 v[68:83], v[28:31], v[52:59], v84
    ds_read_b128 v[16:19], v4 offset:12288
    v_exp_f32 v62, v62
    v_exp_f32 v63, v63
    s_mov_b64 exec, s[54:55]
    ds_read_b128 v[20:23], v5 offset:9216
    ds_read_b128 v[24:27], v5 offset:9728
    s_mov_b64 exec, -1
    v_exp_f32 v64, v64
    v_exp_f32 v65, v65
    v_exp_f32 v66, v66
    v_exp_f32 v67, v67
    s_mov_b32 m0, s50
    s_add_u32 s50, s50, 8192
    buffer_load_dwordx4 v250, s[24:27], s48 offen lds
    s_add_u32 s48, s48, 352256
    s_setprio 0
    v_exp_f32 v36, v36
    v_exp_f32 v37, v37
    v_smfmac_f32_32x32x32_bf16 v[68:83], v[32:35], v[60:67], v84
    s_waitcnt lgkmcnt(2)
    v_exp_f32 v38, v38
    v_exp_f32 v39, v39
    v_exp_f32 v40, v40
    v_exp_f32 v41, v41
    v_mfma_f32_32x32x16_bf16 v[52:67], v[16:19], v[8:11], 0
    v_exp_f32 v42, v42
    v_exp_f32 v43, v43
    v_exp_f32 v44, v44
    v_exp_f32 v45, v45
    s_waitcnt lgkmcnt(0)
    v_smfmac_f32_32x32x32_bf16 v[68:83], v[20:23], v[36:43], v84
    s_waitcnt vmcnt(3)
    s_barrier
    ds_read_b128 v[12:15], v4 offset:16384
    v_exp_f32 v46, v46
    v_exp_f32 v47, v47
    s_mov_b64 exec, s[54:55]
    ds_read_b128 v[28:31], v5 offset:13312
    ds_read_b128 v[32:35], v5 offset:13824
    s_mov_b64 exec, -1
    v_exp_f32 v48, v48
    v_exp_f32 v49, v49
    v_exp_f32 v50, v50
    v_exp_f32 v51, v51
    s_add_u32 s51, s51, 16384
    s_and_b32 s51, s51, 0x3ffff
    s_add_u32 s56, s51, s52
    s_add_u32 m0, s53, 32768
    s_nop 0
    buffer_load_dwordx4 v2, s[4:7], s56 offen sc1 lds
    s_setprio 3
    v_exp_f32 v52, v52
    v_exp_f32 v53, v53
    v_smfmac_f32_32x32x32_bf16 v[68:83], v[24:27], v[44:51], v84
    s_waitcnt lgkmcnt(2)
    v_exp_f32 v54, v54
    v_exp_f32 v55, v55
    v_exp_f32 v56, v56
    v_exp_f32 v57, v57
    v_mfma_f32_32x32x16_bf16 v[36:51], v[12:15], v[8:11], 0
    v_exp_f32 v58, v58
    v_exp_f32 v59, v59
    v_exp_f32 v60, v60
    v_exp_f32 v61, v61
    s_waitcnt lgkmcnt(0)
    v_smfmac_f32_32x32x32_bf16 v[68:83], v[28:31], v[52:59], v84
    ds_read_b128 v[16:19], v4 offset:20480
    v_exp_f32 v62, v62
    v_exp_f32 v63, v63
    s_mov_b64 exec, s[54:55]
    ds_read_b128 v[20:23], v5 offset:17408
    ds_read_b128 v[24:27], v5 offset:17920
    s_mov_b64 exec, -1
    v_exp_f32 v64, v64
    v_exp_f32 v65, v65
    v_exp_f32 v66, v66
    v_exp_f32 v67, v67
    s_add_u32 m0, s53, 32768
    s_nop 0
    buffer_load_dwordx4 v2, s[4:7], s56 offen offset:1024 sc1 lds
    s_setprio 2
    v_exp_f32 v36, v36
    v_exp_f32 v37, v37
    v_smfmac_f32_32x32x32_bf16 v[68:83], v[32:35], v[60:67], v84
    s_waitcnt lgkmcnt(2)
    v_exp_f32 v38, v38
    v_exp_f32 v39, v39
    v_exp_f32 v40, v40
    v_exp_f32 v41, v41
    v_mfma_f32_32x32x16_bf16 v[52:67], v[16:19], v[8:11], 0
    v_exp_f32 v42, v42
    v_exp_f32 v43, v43
    v_exp_f32 v44, v44
    v_exp_f32 v45, v45
    s_waitcnt lgkmcnt(0)
    v_smfmac_f32_32x32x32_bf16 v[68:83], v[20:23], v[36:43], v84
    ds_read_b128 v[12:15], v4 offset:24576
    v_exp_f32 v46, v46
    v_exp_f32 v47, v47
    s_mov_b64 exec, s[54:55]
    ds_read_b128 v[28:31], v5 offset:21504
    ds_read_b128 v[32:35], v5 offset:22016
    s_mov_b64 exec, -1
    v_exp_f32 v48, v48
    v_exp_f32 v49, v49
    v_exp_f32 v50, v50
    v_exp_f32 v51, v51
    s_setprio 1
    v_exp_f32 v52, v52
    v_exp_f32 v53, v53
    v_smfmac_f32_32x32x32_bf16 v[68:83], v[24:27], v[44:51], v84
    s_waitcnt lgkmcnt(2)
    v_exp_f32 v54, v54
    v_exp_f32 v55, v55
    v_exp_f32 v56, v56
    v_exp_f32 v57, v57
    v_mfma_f32_32x32x16_bf16 v[36:51], v[12:15], v[8:11], 0
    v_exp_f32 v58, v58
    v_exp_f32 v59, v59
    v_exp_f32 v60, v60
    v_exp_f32 v61, v61
    s_waitcnt lgkmcnt(0)
    v_smfmac_f32_32x32x32_bf16 v[68:83], v[28:31], v[52:59], v84
    ds_read_b128 v[16:19], v4 offset:28672
    v_exp_f32 v62, v62
    v_exp_f32 v63, v63
    s_mov_b64 exec, s[54:55]
    ds_read_b128 v[20:23], v5 offset:25600
    ds_read_b128 v[24:27], v5 offset:26112
    s_mov_b64 exec, -1
    v_exp_f32 v64, v64
    v_exp_f32 v65, v65
    v_exp_f32 v66, v66
    v_exp_f32 v67, v67
    s_mov_b32 m0, s50
    s_add_u32 s50, s50, 8192
    buffer_load_dwordx4 v248, s[24:27], s48 offen lds
    s_setprio 0
    v_exp_f32 v36, v36
    v_exp_f32 v37, v37
    v_smfmac_f32_32x32x32_bf16 v[68:83], v[32:35], v[60:67], v84
    s_waitcnt lgkmcnt(2)
    v_exp_f32 v38, v38
    v_exp_f32 v39, v39
    v_exp_f32 v40, v40
    v_exp_f32 v41, v41
    v_mfma_f32_32x32x16_bf16 v[52:67], v[16:19], v[8:11], 0
    v_exp_f32 v42, v42
    v_exp_f32 v43, v43
    v_exp_f32 v44, v44
    v_exp_f32 v45, v45
    s_waitcnt lgkmcnt(0)
    v_smfmac_f32_32x32x32_bf16 v[68:83], v[20:23], v[36:43], v84
    s_waitcnt vmcnt(1)
    s_barrier
    ds_read_b128 v[12:15], v4 offset:32768
    v_exp_f32 v46, v46
    v_exp_f32 v47, v47
    s_mov_b64 exec, s[54:55]
    ds_read_b128 v[28:31], v5 offset:29696
    ds_read_b128 v[32:35], v5 offset:30208
    s_mov_b64 exec, -1
    v_exp_f32 v48, v48
    v_exp_f32 v49, v49
    v_exp_f32 v50, v50
    v_exp_f32 v51, v51
    s_add_u32 s51, s51, 16384
    s_and_b32 s51, s51, 0x3ffff
    s_add_u32 s56, s51, s52
    s_add_u32 m0, s53, 0
    s_nop 0
    buffer_load_dwordx4 v2, s[4:7], s56 offen sc1 lds
    s_setprio 3
    v_exp_f32 v52, v52
    v_exp_f32 v53, v53
    v_smfmac_f32_32x32x32_bf16 v[68:83], v[24:27], v[44:51], v84
    s_waitcnt lgkmcnt(2)
    v_exp_f32 v54, v54
    v_exp_f32 v55, v55
    v_exp_f32 v56, v56
    v_exp_f32 v57, v57
    v_mfma_f32_32x32x16_bf16 v[36:51], v[12:15], v[8:11], 0
    v_exp_f32 v58, v58
    v_exp_f32 v59, v59
    v_exp_f32 v60, v60
    v_exp_f32 v61, v61
    s_waitcnt lgkmcnt(0)
    v_smfmac_f32_32x32x32_bf16 v[68:83], v[28:31], v[52:59], v84
    ds_read_b128 v[16:19], v4 offset:36864
    v_exp_f32 v62, v62
    v_exp_f32 v63, v63
    s_mov_b64 exec, s[54:55]
    ds_read_b128 v[20:23], v5 offset:33792
    ds_read_b128 v[24:27], v5 offset:34304
    s_mov_b64 exec, -1
    v_exp_f32 v64, v64
    v_exp_f32 v65, v65
    v_exp_f32 v66, v66
    v_exp_f32 v67, v67
    s_add_u32 m0, s53, 0
    s_nop 0
    buffer_load_dwordx4 v2, s[4:7], s56 offen offset:1024 sc1 lds
    s_setprio 2
    v_exp_f32 v36, v36
    v_exp_f32 v37, v37
    v_smfmac_f32_32x32x32_bf16 v[68:83], v[32:35], v[60:67], v84
    s_waitcnt lgkmcnt(2)
    v_exp_f32 v38, v38
    v_exp_f32 v39, v39
    v_exp_f32 v40, v40
    v_exp_f32 v41, v41
    v_mfma_f32_32x32x16_bf16 v[52:67], v[16:19], v[8:11], 0
    v_exp_f32 v42, v42
    v_exp_f32 v43, v43
    v_exp_f32 v44, v44
    v_exp_f32 v45, v45
    s_waitcnt lgkmcnt(0)
    v_smfmac_f32_32x32x32_bf16 v[68:83], v[20:23], v[36:43], v84
    ds_read_b128 v[12:15], v4 offset:40960
    v_exp_f32 v46, v46
    v_exp_f32 v47, v47
    s_mov_b64 exec, s[54:55]
    ds_read_b128 v[28:31], v5 offset:37888
    ds_read_b128 v[32:35], v5 offset:38400
    s_mov_b64 exec, -1
    v_exp_f32 v48, v48
    v_exp_f32 v49, v49
    v_exp_f32 v50, v50
    v_exp_f32 v51, v51
    s_setprio 1
    v_exp_f32 v52, v52
    v_exp_f32 v53, v53
    v_smfmac_f32_32x32x32_bf16 v[68:83], v[24:27], v[44:51], v84
    s_waitcnt lgkmcnt(2)
    v_exp_f32 v54, v54
    v_exp_f32 v55, v55
    v_exp_f32 v56, v56
    v_exp_f32 v57, v57
    v_mfma_f32_32x32x16_bf16 v[36:51], v[12:15], v[8:11], 0
    v_exp_f32 v58, v58
    v_exp_f32 v59, v59
    v_exp_f32 v60, v60
    v_exp_f32 v61, v61
    s_waitcnt lgkmcnt(0)
    v_smfmac_f32_32x32x32_bf16 v[68:83], v[28:31], v[52:59], v84
    ds_read_b128 v[16:19], v4 offset:45056
    v_exp_f32 v62, v62
    v_exp_f32 v63, v63
    s_mov_b64 exec, s[54:55]
    ds_read_b128 v[20:23], v5 offset:41984
    ds_read_b128 v[24:27], v5 offset:42496
    s_mov_b64 exec, -1
    v_exp_f32 v64, v64
    v_exp_f32 v65, v65
    v_exp_f32 v66, v66
    v_exp_f32 v67, v67
    s_mov_b32 m0, s50
    s_add_u32 s50, s50, 8192
    buffer_load_dwordx4 v249, s[24:27], s48 offen lds
    s_setprio 0
    v_exp_f32 v36, v36
    v_exp_f32 v37, v37
    v_smfmac_f32_32x32x32_bf16 v[68:83], v[32:35], v[60:67], v84
    s_waitcnt lgkmcnt(2)
    v_exp_f32 v38, v38
    v_exp_f32 v39, v39
    v_exp_f32 v40, v40
    v_exp_f32 v41, v41
    v_mfma_f32_32x32x16_bf16 v[52:67], v[16:19], v[8:11], 0
    v_exp_f32 v42, v42
    v_exp_f32 v43, v43
    v_exp_f32 v44, v44
    v_exp_f32 v45, v45
    s_waitcnt lgkmcnt(0)
    v_smfmac_f32_32x32x32_bf16 v[68:83], v[20:23], v[36:43], v84
    s_waitcnt vmcnt(1)
    s_barrier
    ds_read_b128 v[12:15], v4 offset:0
    v_exp_f32 v46, v46
    v_exp_f32 v47, v47
    s_mov_b64 exec, s[54:55]
    ds_read_b128 v[28:31], v5 offset:46080
    ds_read_b128 v[32:35], v5 offset:46592
    s_mov_b64 exec, -1
    v_exp_f32 v48, v48
    v_exp_f32 v49, v49
    v_exp_f32 v50, v50
    v_exp_f32 v51, v51
    s_add_u32 s51, s51, 16384
    s_and_b32 s51, s51, 0x3ffff
    s_add_u32 s56, s51, s52
    s_add_u32 m0, s53, 16384
    s_nop 0
    buffer_load_dwordx4 v2, s[4:7], s56 offen sc1 lds
    s_setprio 3
    v_exp_f32 v52, v52
    v_exp_f32 v53, v53
    v_smfmac_f32_32x32x32_bf16 v[68:83], v[24:27], v[44:51], v84
    s_waitcnt lgkmcnt(2)
    v_exp_f32 v54, v54
    v_exp_f32 v55, v55
    v_exp_f32 v56, v56
    v_exp_f32 v57, v57
    v_mfma_f32_32x32x16_bf16 v[36:51], v[12:15], v[8:11], 0
    v_exp_f32 v58, v58
    v_exp_f32 v59, v59
    v_exp_f32 v60, v60
    v_exp_f32 v61, v61
    s_waitcnt lgkmcnt(0)
    v_smfmac_f32_32x32x32_bf16 v[68:83], v[28:31], v[52:59], v84
    ds_read_b128 v[16:19], v4 offset:4096
    v_exp_f32 v62, v62
    v_exp_f32 v63, v63
    s_mov_b64 exec, s[54:55]
    ds_read_b128 v[20:23], v5 offset:1024
    ds_read_b128 v[24:27], v5 offset:1536
    s_mov_b64 exec, -1
    v_exp_f32 v64, v64
    v_exp_f32 v65, v65
    v_exp_f32 v66, v66
    v_exp_f32 v67, v67
    s_add_u32 m0, s53, 16384
    s_nop 0
    buffer_load_dwordx4 v2, s[4:7], s56 offen offset:1024 sc1 lds
    s_setprio 2
    v_exp_f32 v36, v36
    v_exp_f32 v37, v37
    v_smfmac_f32_32x32x32_bf16 v[68:83], v[32:35], v[60:67], v84
    s_waitcnt lgkmcnt(2)
    v_exp_f32 v38, v38
    v_exp_f32 v39, v39
    v_exp_f32 v40, v40
    v_exp_f32 v41, v41
    v_mfma_f32_32x32x16_bf16 v[52:67], v[16:19], v[8:11], 0
    v_exp_f32 v42, v42
    v_exp_f32 v43, v43
    v_exp_f32 v44, v44
    v_exp_f32 v45, v45
    s_waitcnt lgkmcnt(0)
    v_smfmac_f32_32x32x32_bf16 v[68:83], v[20:23], v[36:43], v84
    ds_read_b128 v[12:15], v4 offset:8192
    v_exp_f32 v46, v46
    v_exp_f32 v47, v47
    s_mov_b64 exec, s[54:55]
    ds_read_b128 v[28:31], v5 offset:5120
    ds_read_b128 v[32:35], v5 offset:5632
    s_mov_b64 exec, -1
    v_exp_f32 v48, v48
    v_exp_f32 v49, v49
    v_exp_f32 v50, v50
    v_exp_f32 v51, v51
    s_setprio 1
    v_exp_f32 v52, v52
    v_exp_f32 v53, v53
    v_smfmac_f32_32x32x32_bf16 v[68:83], v[24:27], v[44:51], v84
    s_waitcnt lgkmcnt(2)
    v_exp_f32 v54, v54
    v_exp_f32 v55, v55
    v_exp_f32 v56, v56
    v_exp_f32 v57, v57
    v_mfma_f32_32x32x16_bf16 v[36:51], v[12:15], v[8:11], 0
    v_exp_f32 v58, v58
    v_exp_f32 v59, v59
    v_exp_f32 v60, v60
    v_exp_f32 v61, v61
    s_waitcnt lgkmcnt(0)
    v_smfmac_f32_32x32x32_bf16 v[68:83], v[28:31], v[52:59], v84
    ds_read_b128 v[16:19], v4 offset:12288
    v_exp_f32 v62, v62
    v_exp_f32 v63, v63
    s_mov_b64 exec, s[54:55]
    ds_read_b128 v[20:23], v5 offset:9216
    ds_read_b128 v[24:27], v5 offset:9728
    s_mov_b64 exec, -1
    v_exp_f32 v64, v64
    v_exp_f32 v65, v65
    v_exp_f32 v66, v66
    v_exp_f32 v67, v67
    s_mov_b32 m0, s50
    s_add_u32 s50, s50, 8192
    buffer_load_dwordx4 v250, s[24:27], s48 offen lds
    s_add_u32 s48, s48, 352256
    s_setprio 0
    v_exp_f32 v36, v36
    v_exp_f32 v37, v37
    v_smfmac_f32_32x32x32_bf16 v[68:83], v[32:35], v[60:67], v84
    s_waitcnt lgkmcnt(2)
    v_exp_f32 v38, v38
    v_exp_f32 v39, v39
    v_exp_f32 v40, v40
    v_exp_f32 v41, v41
    v_mfma_f32_32x32x16_bf16 v[52:67], v[16:19], v[8:11], 0
    v_exp_f32 v42, v42
    v_exp_f32 v43, v43
    v_exp_f32 v44, v44
    v_exp_f32 v45, v45
    s_waitcnt lgkmcnt(0)
    v_smfmac_f32_32x32x32_bf16 v[68:83], v[20:23], v[36:43], v84
    s_waitcnt vmcnt(1)
    s_barrier
    ds_read_b128 v[12:15], v4 offset:16384
    v_exp_f32 v46, v46
    v_exp_f32 v47, v47
    s_mov_b64 exec, s[54:55]
    ds_read_b128 v[28:31], v5 offset:13312
    ds_read_b128 v[32:35], v5 offset:13824
    s_mov_b64 exec, -1
    v_exp_f32 v48, v48
    v_exp_f32 v49, v49
    v_exp_f32 v50, v50
    v_exp_f32 v51, v51
    s_add_u32 s51, s51, 16384
    s_and_b32 s51, s51, 0x3ffff
    s_add_u32 s56, s51, s52
    s_add_u32 m0, s53, 32768
    s_nop 0
    buffer_load_dwordx4 v2, s[4:7], s56 offen sc1 lds
    s_setprio 3
    v_exp_f32 v52, v52
    v_exp_f32 v53, v53
    v_smfmac_f32_32x32x32_bf16 v[68:83], v[24:27], v[44:51], v84
    s_waitcnt lgkmcnt(2)
    v_exp_f32 v54, v54
    v_exp_f32 v55, v55
    v_exp_f32 v56, v56
    v_exp_f32 v57, v57
    v_mfma_f32_32x32x16_bf16 v[36:51], v[12:15], v[8:11], 0
    v_exp_f32 v58, v58
    v_exp_f32 v59, v59
    v_exp_f32 v60, v60
    v_exp_f32 v61, v61
    s_waitcnt lgkmcnt(0)
    v_smfmac_f32_32x32x32_bf16 v[68:83], v[28:31], v[52:59], v84
    ds_read_b128 v[16:19], v4 offset:20480
    v_exp_f32 v62, v62
    v_exp_f32 v63, v63
    s_mov_b64 exec, s[54:55]
    ds_read_b128 v[20:23], v5 offset:17408
    ds_read_b128 v[24:27], v5 offset:17920
    s_mov_b64 exec, -1
    v_exp_f32 v64, v64
    v_exp_f32 v65, v65
    v_exp_f32 v66, v66
    v_exp_f32 v67, v67
    s_add_u32 m0, s53, 32768
    s_nop 0
    buffer_load_dwordx4 v2, s[4:7], s56 offen offset:1024 sc1 lds
    s_mov_b32 s57, 2
    v_and_b32 v90, 15, v1
    v_lshlrev_b32 v90, 2, v90
    s_lshl_b32 s46, s43, 7
    s_add_u32 s46, s46, 15785984
    buffer_load_dword v88, v90, s[4:7], s46 offen sc1
    s_sub_u32 s50, s50, 147456
    s_and_b32 s46, s2, 0xf8
    s_add_u32 s46, s46, s40
    s_mul_i32 s46, s46, 9
    s_add_u32 s46, s46, 5504
    v_min_u32 v91, 8, v1
    v_add_u32 v91, s46, v91
    v_lshlrev_b32 v91, 7, v91
.Lb_loop2:
    s_setprio 2
    v_exp_f32 v36, v36
    v_exp_f32 v37, v37
    v_smfmac_f32_32x32x32_bf16 v[68:83], v[32:35], v[60:67], v84
    s_waitcnt lgkmcnt(2)
    v_exp_f32 v38, v38
    v_exp_f32 v39, v39
    v_exp_f32 v40, v40
    v_exp_f32 v41, v41
    v_mfma_f32_32x32x16_bf16 v[52:67], v[16:19], v[8:11], 0
    v_exp_f32 v42, v42
    v_exp_f32 v43, v43
    v_exp_f32 v44, v44
    v_exp_f32 v45, v45
    s_waitcnt lgkmcnt(0)
    v_smfmac_f32_32x32x32_bf16 v[68:83], v[20:23], v[36:43], v84
    ds_read_b128 v[12:15], v4 offset:24576
    v_exp_f32 v46, v46
    v_exp_f32 v47, v47
    s_mov_b64 exec, s[54:55]
    ds_read_b128 v[28:31], v5 offset:21504
    ds_read_b128 v[32:35], v5 offset:22016
    s_mov_b64 exec, -1
    v_exp_f32 v48, v48
    v_exp_f32 v49, v49
    v_exp_f32 v50, v50
    v_exp_f32 v51, v51
    s_setprio 1
    v_exp_f32 v52, v52
    v_exp_f32 v53, v53
    v_smfmac_f32_32x32x32_bf16 v[68:83], v[24:27], v[44:51], v84
    s_waitcnt lgkmcnt(2)
    v_exp_f32 v54, v54
    v_exp_f32 v55, v55
    v_exp_f32 v56, v56
    v_exp_f32 v57, v57
    v_mfma_f32_32x32x16_bf16 v[36:51], v[12:15], v[8:11], 0
    v_exp_f32 v58, v58
    v_exp_f32 v59, v59
    v_exp_f32 v60, v60
    v_exp_f32 v61, v61
    s_waitcnt lgkmcnt(0)
    v_smfmac_f32_32x32x32_bf16 v[68:83], v[28:31], v[52:59], v84
    ds_read_b128 v[16:19], v4 offset:28672
    v_exp_f32 v62, v62
    v_exp_f32 v63, v63
    s_mov_b64 exec, s[54:55]
    ds_read_b128 v[20:23], v5 offset:25600
    ds_read_b128 v[24:27], v5 offset:26112
    s_mov_b64 exec, -1
    v_exp_f32 v64, v64
    v_exp_f32 v65, v65
    v_exp_f32 v66, v66
    v_exp_f32 v67, v67
    s_mov_b32 m0, s37
    s_add_u32 s37, s37, 8192
    buffer_load_dwordx4 v3, s[16:19], s49 offen lds
    s_add_u32 s49, s49, 65536
    s_setprio 0
    v_exp_f32 v36, v36
    v_exp_f32 v37, v37
    v_smfmac_f32_32x32x32_bf16 v[68:83], v[32:35], v[60:67], v84
    s_waitcnt lgkmcnt(2)
    v_exp_f32 v38, v38
    v_exp_f32 v39, v39
    v_exp_f32 v40, v40
    v_exp_f32 v41, v41
    v_mfma_f32_32x32x16_bf16 v[52:67], v[16:19], v[8:11], 0
    v_exp_f32 v42, v42
    v_exp_f32 v43, v43
    v_exp_f32 v44, v44
    v_exp_f32 v45, v45
    s_waitcnt lgkmcnt(0)
    v_smfmac_f32_32x32x32_bf16 v[68:83], v[20:23], v[36:43], v84
    s_waitcnt vmcnt(1)
    s_barrier
    ds_read_b128 v[12:15], v4 offset:32768
    v_exp_f32 v46, v46
    v_exp_f32 v47, v47
    s_mov_b64 exec, s[54:55]
    ds_read_b128 v[28:31], v5 offset:29696
    ds_read_b128 v[32:35], v5 offset:30208
    s_mov_b64 exec, -1
    v_exp_f32 v48, v48
    v_exp_f32 v49, v49
    v_exp_f32 v50, v50
    v_exp_f32 v51, v51
    s_add_u32 s51, s51, 16384
    s_and_b32 s51, s51, 0x3ffff
    s_add_u32 s56, s51, s52
    s_add_u32 m0, s53, 0
    s_nop 0
    buffer_load_dwordx4 v2, s[4:7], s56 offen sc1 lds
    s_setprio 3
    v_exp_f32 v52, v52
    v_exp_f32 v53, v53
    v_smfmac_f32_32x32x32_bf16 v[68:83], v[24:27], v[44:51], v84
    s_waitcnt lgkmcnt(2)
    v_exp_f32 v54, v54
    v_exp_f32 v55, v55
    v_exp_f32 v56, v56
    v_exp_f32 v57, v57
    v_mfma_f32_32x32x16_bf16 v[36:51], v[12:15], v[8:11], 0
    v_exp_f32 v58, v58
    v_exp_f32 v59, v59
    v_exp_f32 v60, v60
    v_exp_f32 v61, v61
    s_waitcnt lgkmcnt(0)
    v_smfmac_f32_32x32x32_bf16 v[68:83], v[28:31], v[52:59], v84
    ds_read_b128 v[16:19], v4 offset:36864
    v_exp_f32 v62, v62
    v_exp_f32 v63, v63
    s_mov_b64 exec, s[54:55]
    ds_read_b128 v[20:23], v5 offset:33792
    ds_read_b128 v[24:27], v5 offset:34304
    s_mov_b64 exec, -1
    v_exp_f32 v64, v64
    v_exp_f32 v65, v65
    v_exp_f32 v66, v66
    v_exp_f32 v67, v67
    s_add_u32 m0, s53, 0
    s_nop 0
    buffer_load_dwordx4 v2, s[4:7], s56 offen offset:1024 sc1 lds
    s_setprio 2
    v_exp_f32 v36, v36
    v_exp_f32 v37, v37
    v_smfmac_f32_32x32x32_bf16 v[68:83], v[32:35], v[60:67], v84
    s_waitcnt lgkmcnt(2)
    v_exp_f32 v38, v38
    v_exp_f32 v39, v39
    v_exp_f32 v40, v40
    v_exp_f32 v41, v41
    v_mfma_f32_32x32x16_bf16 v[52:67], v[16:19], v[8:11], 0
    v_exp_f32 v42, v42
    v_exp_f32 v43, v43
    v_exp_f32 v44, v44
    v_exp_f32 v45, v45
    s_waitcnt lgkmcnt(0)
    v_smfmac_f32_32x32x32_bf16 v[68:83], v[20:23], v[36:43], v84
    ds_read_b128 v[12:15], v4 offset:40960
    v_exp_f32 v46, v46
    v_exp_f32 v47, v47
    s_mov_b64 exec, s[54:55]
    ds_read_b128 v[28:31], v5 offset:37888
    ds_read_b128 v[32:35], v5 offset:38400
    s_mov_b64 exec, -1
    v_exp_f32 v48, v48
    v_exp_f32 v49, v49
    v_exp_f32 v50, v50
    v_exp_f32 v51, v51
    s_setprio 1
    v_exp_f32 v52, v52
    v_exp_f32 v53, v53
    v_smfmac_f32_32x32x32_bf16 v[68:83], v[24:27], v[44:51], v84
    s_waitcnt lgkmcnt(2)
    v_exp_f32 v54, v54
    v_exp_f32 v55, v55
    v_exp_f32 v56, v56
    v_exp_f32 v57, v57
    v_mfma_f32_32x32x16_bf16 v[36:51], v[12:15], v[8:11], 0
    v_exp_f32 v58, v58
    v_exp_f32 v59, v59
    v_exp_f32 v60, v60
    v_exp_f32 v61, v61
    s_waitcnt lgkmcnt(0)
    v_smfmac_f32_32x32x32_bf16 v[68:83], v[28:31], v[52:59], v84
    ds_read_b128 v[16:19], v4 offset:45056
    v_exp_f32 v62, v62
    v_exp_f32 v63, v63
    s_mov_b64 exec, s[54:55]
    ds_read_b128 v[20:23], v5 offset:41984
    ds_read_b128 v[24:27], v5 offset:42496
    s_mov_b64 exec, -1
    v_exp_f32 v64, v64
    v_exp_f32 v65, v65
    v_exp_f32 v66, v66
    v_exp_f32 v67, v67
    s_mov_b32 m0, s37
    s_add_u32 s37, s37, 8192
    buffer_load_dwordx4 v3, s[16:19], s49 offen lds
    s_add_u32 s49, s49, 65536
    s_setprio 0
    v_exp_f32 v36, v36
    v_exp_f32 v37, v37
    v_smfmac_f32_32x32x32_bf16 v[68:83], v[32:35], v[60:67], v84
    s_waitcnt lgkmcnt(2)
    v_exp_f32 v38, v38
    v_exp_f32 v39, v39
    v_exp_f32 v40, v40
    v_exp_f32 v41, v41
    v_mfma_f32_32x32x16_bf16 v[52:67], v[16:19], v[8:11], 0
    v_exp_f32 v42, v42
    v_exp_f32 v43, v43
    v_exp_f32 v44, v44
    v_exp_f32 v45, v45
    s_waitcnt lgkmcnt(0)
    v_smfmac_f32_32x32x32_bf16 v[68:83], v[20:23], v[36:43], v84
    s_waitcnt vmcnt(1)
    s_barrier
    ds_read_b128 v[12:15], v4 offset:0
    v_exp_f32 v46, v46
    v_exp_f32 v47, v47
    s_mov_b64 exec, s[54:55]
    ds_read_b128 v[28:31], v5 offset:46080
    ds_read_b128 v[32:35], v5 offset:46592
    s_mov_b64 exec, -1
    v_exp_f32 v48, v48
    v_exp_f32 v49, v49
    v_exp_f32 v50, v50
    v_exp_f32 v51, v51
    s_add_u32 s51, s51, 16384
    s_and_b32 s51, s51, 0x3ffff
    s_add_u32 s56, s51, s52
    s_add_u32 m0, s53, 16384
    s_nop 0
    buffer_load_dwordx4 v2, s[4:7], s56 offen sc1 lds
    s_setprio 3
    v_exp_f32 v52, v52
    v_exp_f32 v53, v53
    v_smfmac_f32_32x32x32_bf16 v[68:83], v[24:27], v[44:51], v84
    s_waitcnt lgkmcnt(2)
    v_exp_f32 v54, v54
    v_exp_f32 v55, v55
    v_exp_f32 v56, v56
    v_exp_f32 v57, v57
    v_mfma_f32_32x32x16_bf16 v[36:51], v[12:15], v[8:11], 0
    v_exp_f32 v58, v58
    v_exp_f32 v59, v59
    v_exp_f32 v60, v60
    v_exp_f32 v61, v61
    s_waitcnt lgkmcnt(0)
    v_smfmac_f32_32x32x32_bf16 v[68:83], v[28:31], v[52:59], v84
    ds_read_b128 v[16:19], v4 offset:4096
    v_exp_f32 v62, v62
    v_exp_f32 v63, v63
    s_mov_b64 exec, s[54:55]
    ds_read_b128 v[20:23], v5 offset:1024
    ds_read_b128 v[24:27], v5 offset:1536
    s_mov_b64 exec, -1
    v_exp_f32 v64, v64
    v_exp_f32 v65, v65
    v_exp_f32 v66, v66
    v_exp_f32 v67, v67
    s_add_u32 m0, s53, 16384
    s_nop 0
    buffer_load_dwordx4 v2, s[4:7], s56 offen offset:1024 sc1 lds
    s_setprio 2
    v_exp_f32 v36, v36
    v_exp_f32 v37, v37
    v_smfmac_f32_32x32x32_bf16 v[68:83], v[32:35], v[60:67], v84
    s_waitcnt lgkmcnt(2)
    v_exp_f32 v38, v38
    v_exp_f32 v39, v39
    v_exp_f32 v40, v40
    v_exp_f32 v41, v41
    v_mfma_f32_32x32x16_bf16 v[52:67], v[16:19], v[8:11], 0
    v_exp_f32 v42, v42
    v_exp_f32 v43, v43
    v_exp_f32 v44, v44
    v_exp_f32 v45, v45
    s_waitcnt lgkmcnt(0)
    v_smfmac_f32_32x32x32_bf16 v[68:83], v[20:23], v[36:43], v84
    ds_read_b128 v[12:15], v4 offset:8192
    v_exp_f32 v46, v46
    v_exp_f32 v47, v47
    s_mov_b64 exec, s[54:55]
    ds_read_b128 v[28:31], v5 offset:5120
    ds_read_b128 v[32:35], v5 offset:5632
    s_mov_b64 exec, -1
    v_exp_f32 v48, v48
    v_exp_f32 v49, v49
    v_exp_f32 v50, v50
    v_exp_f32 v51, v51
    s_setprio 1
    v_exp_f32 v52, v52
    v_exp_f32 v53, v53
    v_smfmac_f32_32x32x32_bf16 v[68:83], v[24:27], v[44:51], v84
    s_waitcnt lgkmcnt(2)
    v_exp_f32 v54, v54
    v_exp_f32 v55, v55
    v_exp_f32 v56, v56
    v_exp_f32 v57, v57
    v_mfma_f32_32x32x16_bf16 v[36:51], v[12:15], v[8:11], 0
    v_exp_f32 v58, v58
    v_exp_f32 v59, v59
    v_exp_f32 v60, v60
    v_exp_f32 v61, v61
    s_waitcnt lgkmcnt(0)
    v_smfmac_f32_32x32x32_bf16 v[68:83], v[28:31], v[52:59], v84
    ds_read_b128 v[16:19], v4 offset:12288
    v_exp_f32 v62, v62
    v_exp_f32 v63, v63
    s_mov_b64 exec, s[54:55]
    ds_read_b128 v[20:23], v5 offset:9216
    ds_read_b128 v[24:27], v5 offset:9728
    s_mov_b64 exec, -1
    v_exp_f32 v64, v64
    v_exp_f32 v65, v65
    v_exp_f32 v66, v66
    v_exp_f32 v67, v67
    s_mov_b32 m0, s37
    s_add_u32 s37, s37, 8192
    buffer_load_dwordx4 v3, s[16:19], s49 offen lds
    s_add_u32 s49, s49, 65536
    s_setprio 0
    v_exp_f32 v36, v36
    v_exp_f32 v37, v37
    v_smfmac_f32_32x32x32_bf16 v[68:83], v[32:35], v[60:67], v84
    s_waitcnt lgkmcnt(2)
    v_exp_f32 v38, v38
    v_exp_f32 v39, v39
    v_exp_f32 v40, v40
    v_exp_f32 v41, v41
    v_mfma_f32_32x32x16_bf16 v[52:67], v[16:19], v[8:11], 0
    v_exp_f32 v42, v42
    v_exp_f32 v43, v43
    v_exp_f32 v44, v44
    v_exp_f32 v45, v45
    s_waitcnt lgkmcnt(0)
    v_smfmac_f32_32x32x32_bf16 v[68:83], v[20:23], v[36:43], v84
    s_waitcnt vmcnt(1)
    s_barrier
    ds_read_b128 v[12:15], v4 offset:16384
    v_exp_f32 v46, v46
    v_exp_f32 v47, v47
    s_mov_b64 exec, s[54:55]
    ds_read_b128 v[28:31], v5 offset:13312
    ds_read_b128 v[32:35], v5 offset:13824
    s_mov_b64 exec, -1
    v_exp_f32 v48, v48
    v_exp_f32 v49, v49
    v_exp_f32 v50, v50
    v_exp_f32 v51, v51
    s_add_u32 s51, s51, 16384
    s_and_b32 s51, s51, 0x3ffff
    s_add_u32 s56, s51, s52
    s_add_u32 m0, s53, 32768
    s_nop 0
    buffer_load_dwordx4 v2, s[4:7], s56 offen sc1 lds
    s_setprio 3
    v_exp_f32 v52, v52
    v_exp_f32 v53, v53
    v_smfmac_f32_32x32x32_bf16 v[68:83], v[24:27], v[44:51], v84
    s_waitcnt lgkmcnt(2)
    v_exp_f32 v54, v54
    v_exp_f32 v55, v55
    v_exp_f32 v56, v56
    v_exp_f32 v57, v57
    v_mfma_f32_32x32x16_bf16 v[36:51], v[12:15], v[8:11], 0
    v_exp_f32 v58, v58
    v_exp_f32 v59, v59
    v_exp_f32 v60, v60
    v_exp_f32 v61, v61
    s_waitcnt lgkmcnt(0)
    v_smfmac_f32_32x32x32_bf16 v[68:83], v[28:31], v[52:59], v84
    ds_read_b128 v[16:19], v4 offset:20480
    v_exp_f32 v62, v62
    v_exp_f32 v63, v63
    s_mov_b64 exec, s[54:55]
    ds_read_b128 v[20:23], v5 offset:17408
    ds_read_b128 v[24:27], v5 offset:17920
    s_mov_b64 exec, -1
    v_exp_f32 v64, v64
    v_exp_f32 v65, v65
    v_exp_f32 v66, v66
    v_exp_f32 v67, v67
    s_add_u32 m0, s53, 32768
    s_nop 0
    buffer_load_dwordx4 v2, s[4:7], s56 offen offset:1024 sc1 lds
    s_setprio 2
    v_exp_f32 v36, v36
    v_exp_f32 v37, v37
    v_smfmac_f32_32x32x32_bf16 v[68:83], v[32:35], v[60:67], v84
    s_waitcnt lgkmcnt(2)
    v_exp_f32 v38, v38
    v_exp_f32 v39, v39
    v_exp_f32 v40, v40
    v_exp_f32 v41, v41
    v_mfma_f32_32x32x16_bf16 v[52:67], v[16:19], v[8:11], 0
    v_exp_f32 v42, v42
    v_exp_f32 v43, v43
    v_exp_f32 v44, v44
    v_exp_f32 v45, v45
    s_waitcnt lgkmcnt(0)
    v_smfmac_f32_32x32x32_bf16 v[68:83], v[20:23], v[36:43], v84
    ds_read_b128 v[12:15], v4 offset:24576
    v_exp_f32 v46, v46
    v_exp_f32 v47, v47
    s_mov_b64 exec, s[54:55]
    ds_read_b128 v[28:31], v5 offset:21504
    ds_read_b128 v[32:35], v5 offset:22016
    s_mov_b64 exec, -1
    v_exp_f32 v48, v48
    v_exp_f32 v49, v49
    v_exp_f32 v50, v50
    v_exp_f32 v51, v51
    s_mov_b32 exec_lo, 0x1ff
    s_mov_b32 exec_hi, 0x0
    buffer_load_dword v252, v91, s[24:27], 0 offen
    s_mov_b64 exec, -1
    s_setprio 1
    v_exp_f32 v52, v52
    v_exp_f32 v53, v53
    v_smfmac_f32_32x32x32_bf16 v[68:83], v[24:27], v[44:51], v84
    s_waitcnt lgkmcnt(2)
    v_exp_f32 v54, v54
    v_exp_f32 v55, v55
    v_exp_f32 v56, v56
    v_exp_f32 v57, v57
    v_mfma_f32_32x32x16_bf16 v[36:51], v[12:15], v[8:11], 0
    v_exp_f32 v58, v58
    v_exp_f32 v59, v59
    v_exp_f32 v60, v60
    v_exp_f32 v61, v61
    s_waitcnt lgkmcnt(0)
    v_smfmac_f32_32x32x32_bf16 v[68:83], v[28:31], v[52:59], v84
    ds_read_b128 v[16:19], v4 offset:28672
    v_exp_f32 v62, v62
    v_exp_f32 v63, v63
    s_mov_b64 exec, s[54:55]
    ds_read_b128 v[20:23], v5 offset:25600
    ds_read_b128 v[24:27], v5 offset:26112
    s_mov_b64 exec, -1
    v_exp_f32 v64, v64
    v_exp_f32 v65, v65
    v_exp_f32 v66, v66
    v_exp_f32 v67, v67
    s_mov_b32 m0, s37
    s_add_u32 s37, s37, 8192
    buffer_load_dwordx4 v3, s[16:19], s49 offen lds
    s_add_u32 s49, s49, 65536
    s_setprio 0
    v_exp_f32 v36, v36
    v_exp_f32 v37, v37
    v_smfmac_f32_32x32x32_bf16 v[68:83], v[32:35], v[60:67], v84
    s_waitcnt lgkmcnt(2)
    v_exp_f32 v38, v38
    v_exp_f32 v39, v39
    v_exp_f32 v40, v40
    v_exp_f32 v41, v41
    v_mfma_f32_32x32x16_bf16 v[52:67], v[16:19], v[8:11], 0
    v_exp_f32 v42, v42
    v_exp_f32 v43, v43
    v_exp_f32 v44, v44
    v_exp_f32 v45, v45
    s_waitcnt lgkmcnt(0)
    v_smfmac_f32_32x32x32_bf16 v[68:83], v[20:23], v[36:43], v84
    s_waitcnt vmcnt(2)
    s_barrier
    ds_read_b128 v[12:15], v4 offset:32768
    v_exp_f32 v46, v46
    v_exp_f32 v47, v47
    s_mov_b64 exec, s[54:55]
    ds_read_b128 v[28:31], v5 offset:29696
    ds_read_b128 v[32:35], v5 offset:30208
    s_mov_b64 exec, -1
    v_exp_f32 v48, v48
    v_exp_f32 v49, v49
    v_exp_f32 v50, v50
    v_exp_f32 v51, v51
    s_add_u32 s51, s51, 16384
    s_and_b32 s51, s51, 0x3ffff
    s_add_u32 s56, s51, s52
    s_add_u32 m0, s53, 0
    s_nop 0
    buffer_load_dwordx4 v2, s[4:7], s56 offen sc1 lds
    s_setprio 3
    v_exp_f32 v52, v52
    v_exp_f32 v53, v53
    v_smfmac_f32_32x32x32_bf16 v[68:83], v[24:27], v[44:51], v84
    s_waitcnt lgkmcnt(2)
    v_exp_f32 v54, v54
    v_exp_f32 v55, v55
    v_exp_f32 v56, v56
    v_exp_f32 v57, v57
    v_mfma_f32_32x32x16_bf16 v[36:51], v[12:15], v[8:11], 0
    v_exp_f32 v58, v58
    v_exp_f32 v59, v59
    v_exp_f32 v60, v60
    v_exp_f32 v61, v61
    s_waitcnt lgkmcnt(0)
    v_smfmac_f32_32x32x32_bf16 v[68:83], v[28:31], v[52:59], v84
    ds_read_b128 v[16:19], v4 offset:36864
    v_exp_f32 v62, v62
    v_exp_f32 v63, v63
    s_mov_b64 exec, s[54:55]
    ds_read_b128 v[20:23], v5 offset:33792
    ds_read_b128 v[24:27], v5 offset:34304
    s_mov_b64 exec, -1
    v_exp_f32 v64, v64
    v_exp_f32 v65, v65
    v_exp_f32 v66, v66
    v_exp_f32 v67, v67
    s_add_u32 m0, s53, 0
    s_nop 0
    buffer_load_dwordx4 v2, s[4:7], s56 offen offset:1024 sc1 lds
    s_setprio 2
    v_exp_f32 v36, v36
    v_exp_f32 v37, v37
    v_smfmac_f32_32x32x32_bf16 v[68:83], v[32:35], v[60:67], v84
    s_waitcnt lgkmcnt(2)
    v_exp_f32 v38, v38
    v_exp_f32 v39, v39
    v_exp_f32 v40, v40
    v_exp_f32 v41, v41
    v_mfma_f32_32x32x16_bf16 v[52:67], v[16:19], v[8:11], 0
    v_exp_f32 v42, v42
    v_exp_f32 v43, v43
    v_exp_f32 v44, v44
    v_exp_f32 v45, v45
    s_waitcnt lgkmcnt(0)
    v_smfmac_f32_32x32x32_bf16 v[68:83], v[20:23], v[36:43], v84
    ds_read_b128 v[12:15], v4 offset:40960
    v_exp_f32 v46, v46
    v_exp_f32 v47, v47
    s_mov_b64 exec, s[54:55]
    ds_read_b128 v[28:31], v5 offset:37888
    ds_read_b128 v[32:35], v5 offset:38400
    s_mov_b64 exec, -1
    v_exp_f32 v48, v48
    v_exp_f32 v49, v49
    v_exp_f32 v50, v50
    v_exp_f32 v51, v51
    s_mov_b32 exec_lo, 0x1ff
    s_mov_b32 exec_hi, 0x0
    buffer_load_dword v252, v251, s[28:31], 0 offen
    s_mov_b64 exec, -1
    s_setprio 1
    v_exp_f32 v52, v52
    v_exp_f32 v53, v53
    v_smfmac_f32_32x32x32_bf16 v[68:83], v[24:27], v[44:51], v84
    s_waitcnt lgkmcnt(2)
    v_exp_f32 v54, v54
    v_exp_f32 v55, v55
    v_exp_f32 v56, v56
    v_exp_f32 v57, v57
    v_mfma_f32_32x32x16_bf16 v[36:51], v[12:15], v[8:11], 0
    v_exp_f32 v58, v58
    v_exp_f32 v59, v59
    v_exp_f32 v60, v60
    v_exp_f32 v61, v61
    s_waitcnt lgkmcnt(0)
    v_smfmac_f32_32x32x32_bf16 v[68:83], v[28:31], v[52:59], v84
    ds_read_b128 v[16:19], v4 offset:45056
    v_exp_f32 v62, v62
    v_exp_f32 v63, v63
    s_mov_b64 exec, s[54:55]
    ds_read_b128 v[20:23], v5 offset:41984
    ds_read_b128 v[24:27], v5 offset:42496
    s_mov_b64 exec, -1
    v_exp_f32 v64, v64
    v_exp_f32 v65, v65
    v_exp_f32 v66, v66
    v_exp_f32 v67, v67
    s_mov_b32 m0, s37
    s_add_u32 s37, s37, 8192
    buffer_load_dwordx4 v3, s[16:19], s49 offen lds
    s_add_u32 s49, s49, 65536
    s_setprio 0
    v_exp_f32 v36, v36
    v_exp_f32 v37, v37
    v_smfmac_f32_32x32x32_bf16 v[68:83], v[32:35], v[60:67], v84
    s_waitcnt lgkmcnt(2)
    v_exp_f32 v38, v38
    v_exp_f32 v39, v39
    v_exp_f32 v40, v40
    v_exp_f32 v41, v41
    v_mfma_f32_32x32x16_bf16 v[52:67], v[16:19], v[8:11], 0
    v_exp_f32 v42, v42
    v_exp_f32 v43, v43
    v_exp_f32 v44, v44
    v_exp_f32 v45, v45
    s_waitcnt lgkmcnt(0)
    v_smfmac_f32_32x32x32_bf16 v[68:83], v[20:23], v[36:43], v84
    s_waitcnt vmcnt(2)
    s_barrier
    ds_read_b128 v[12:15], v4 offset:0
    v_exp_f32 v46, v46
    v_exp_f32 v47, v47
    s_mov_b64 exec, s[54:55]
    ds_read_b128 v[28:31], v5 offset:46080
    ds_read_b128 v[32:35], v5 offset:46592
    s_mov_b64 exec, -1
    v_exp_f32 v48, v48
    v_exp_f32 v49, v49
    v_exp_f32 v50, v50
    v_exp_f32 v51, v51
    s_add_u32 s51, s51, 16384
    s_and_b32 s51, s51, 0x3ffff
    s_add_u32 s56, s51, s52
    s_add_u32 m0, s53, 16384
    s_nop 0
    buffer_load_dwordx4 v2, s[4:7], s56 offen sc1 lds
    s_setprio 3
    v_exp_f32 v52, v52
    v_exp_f32 v53, v53
    v_smfmac_f32_32x32x32_bf16 v[68:83], v[24:27], v[44:51], v84
    s_waitcnt lgkmcnt(2)
    v_exp_f32 v54, v54
    v_exp_f32 v55, v55
    v_exp_f32 v56, v56
    v_exp_f32 v57, v57
    v_mfma_f32_32x32x16_bf16 v[36:51], v[12:15], v[8:11], 0
    v_exp_f32 v58, v58
    v_exp_f32 v59, v59
    v_exp_f32 v60, v60
    v_exp_f32 v61, v61
    s_waitcnt lgkmcnt(0)
    v_smfmac_f32_32x32x32_bf16 v[68:83], v[28:31], v[52:59], v84
    ds_read_b128 v[16:19], v4 offset:4096
    v_exp_f32 v62, v62
    v_exp_f32 v63, v63
    s_mov_b64 exec, s[54:55]
    ds_read_b128 v[20:23], v5 offset:1024
    ds_read_b128 v[24:27], v5 offset:1536
    s_mov_b64 exec, -1
    v_exp_f32 v64, v64
    v_exp_f32 v65, v65
    v_exp_f32 v66, v66
    v_exp_f32 v67, v67
    s_add_u32 m0, s53, 16384
    s_nop 0
    buffer_load_dwordx4 v2, s[4:7], s56 offen offset:1024 sc1 lds
    s_setprio 2
    v_exp_f32 v36, v36
    v_exp_f32 v37, v37
    v_smfmac_f32_32x32x32_bf16 v[68:83], v[32:35], v[60:67], v84
    s_waitcnt lgkmcnt(2)
    v_exp_f32 v38, v38
    v_exp_f32 v39, v39
    v_exp_f32 v40, v40
    v_exp_f32 v41, v41
    v_mfma_f32_32x32x16_bf16 v[52:67], v[16:19], v[8:11], 0
    v_exp_f32 v42, v42
    v_exp_f32 v43, v43
    v_exp_f32 v44, v44
    v_exp_f32 v45, v45
    s_waitcnt lgkmcnt(0)
    v_smfmac_f32_32x32x32_bf16 v[68:83], v[20:23], v[36:43], v84
    ds_read_b128 v[12:15], v4 offset:8192
    v_exp_f32 v46, v46
    v_exp_f32 v47, v47
    s_mov_b64 exec, s[54:55]
    ds_read_b128 v[28:31], v5 offset:5120
    ds_read_b128 v[32:35], v5 offset:5632
    s_mov_b64 exec, -1
    v_exp_f32 v48, v48
    v_exp_f32 v49, v49
    v_exp_f32 v50, v50
    v_exp_f32 v51, v51
    s_mov_b32 exec_lo, 0x3fe00
    s_mov_b32 exec_hi, 0x0
    buffer_load_dword v252, v251, s[28:31], 0 offen
    s_mov_b64 exec, -1
    s_setprio 1
    v_exp_f32 v52, v52
    v_exp_f32 v53, v53
    v_smfmac_f32_32x32x32_bf16 v[68:83], v[24:27], v[44:51], v84
    s_waitcnt lgkmcnt(2)
    v_exp_f32 v54, v54
    v_exp_f32 v55, v55
    v_exp_f32 v56, v56
    v_exp_f32 v57, v57
    v_mfma_f32_32x32x16_bf16 v[36:51], v[12:15], v[8:11], 0
    v_exp_f32 v58, v58
    v_exp_f32 v59, v59
    v_exp_f32 v60, v60
    v_exp_f32 v61, v61
    s_waitcnt lgkmcnt(0)
    v_smfmac_f32_32x32x32_bf16 v[68:83], v[28:31], v[52:59], v84
    ds_read_b128 v[16:19], v4 offset:12288
    v_exp_f32 v62, v62
    v_exp_f32 v63, v63
    s_mov_b64 exec, s[54:55]
    ds_read_b128 v[20:23], v5 offset:9216
    ds_read_b128 v[24:27], v5 offset:9728
    s_mov_b64 exec, -1
    v_exp_f32 v64, v64
    v_exp_f32 v65, v65
    v_exp_f32 v66, v66
    v_exp_f32 v67, v67
    s_mov_b32 m0, s37
    s_add_u32 s37, s37, 8192
    buffer_load_dwordx4 v3, s[16:19], s49 offen lds
    s_add_u32 s49, s49, 65536
    s_setprio 0
    v_exp_f32 v36, v36
    v_exp_f32 v37, v37
    v_smfmac_f32_32x32x32_bf16 v[68:83], v[32:35], v[60:67], v84
    s_waitcnt lgkmcnt(2)
    v_exp_f32 v38, v38
    v_exp_f32 v39, v39
    v_exp_f32 v40, v40
    v_exp_f32 v41, v41
    v_mfma_f32_32x32x16_bf16 v[52:67], v[16:19], v[8:11], 0
    v_exp_f32 v42, v42
    v_exp_f32 v43, v43
    v_exp_f32 v44, v44
    v_exp_f32 v45, v45
    s_waitcnt lgkmcnt(0)
    v_smfmac_f32_32x32x32_bf16 v[68:83], v[20:23], v[36:43], v84
    s_waitcnt vmcnt(2)
    s_barrier
    ds_read_b128 v[12:15], v4 offset:16384
    v_exp_f32 v46, v46
    v_exp_f32 v47, v47
    s_mov_b64 exec, s[54:55]
    ds_read_b128 v[28:31], v5 offset:13312
    ds_read_b128 v[32:35], v5 offset:13824
    s_mov_b64 exec, -1
    v_exp_f32 v48, v48
    v_exp_f32 v49, v49
    v_exp_f32 v50, v50
    v_exp_f32 v51, v51
    s_add_u32 s51, s51, 16384
    s_and_b32 s51, s51, 0x3ffff
    s_add_u32 s56, s51, s52
    s_add_u32 m0, s53, 32768
    s_nop 0
    buffer_load_dwordx4 v2, s[4:7], s56 offen sc1 lds
    s_setprio 3
    v_exp_f32 v52, v52
    v_exp_f32 v53, v53
    v_smfmac_f32_32x32x32_bf16 v[68:83], v[24:27], v[44:51], v84
    s_waitcnt lgkmcnt(2)
    v_exp_f32 v54, v54
    v_exp_f32 v55, v55
    v_exp_f32 v56, v56
    v_exp_f32 v57, v57
    v_mfma_f32_32x32x16_bf16 v[36:51], v[12:15], v[8:11], 0
    v_exp_f32 v58, v58
    v_exp_f32 v59, v59
    v_exp_f32 v60, v60
    v_exp_f32 v61, v61
    s_waitcnt lgkmcnt(0)
    v_smfmac_f32_32x32x32_bf16 v[68:83], v[28:31], v[52:59], v84
    ds_read_b128 v[16:19], v4 offset:20480
    v_exp_f32 v62, v62
    v_exp_f32 v63, v63
    s_mov_b64 exec, s[54:55]
    ds_read_b128 v[20:23], v5 offset:17408
    ds_read_b128 v[24:27], v5 offset:17920
    s_mov_b64 exec, -1
    v_exp_f32 v64, v64
    v_exp_f32 v65, v65
    v_exp_f32 v66, v66
    v_exp_f32 v67, v67
    s_add_u32 m0, s53, 32768
    s_nop 0
    buffer_load_dwordx4 v2, s[4:7], s56 offen offset:1024 sc1 lds
    s_setprio 2
    v_exp_f32 v36, v36
    v_exp_f32 v37, v37
    v_smfmac_f32_32x32x32_bf16 v[68:83], v[32:35], v[60:67], v84
    s_waitcnt lgkmcnt(2)
    v_exp_f32 v38, v38
    v_exp_f32 v39, v39
    v_exp_f32 v40, v40
    v_exp_f32 v41, v41
    v_mfma_f32_32x32x16_bf16 v[52:67], v[16:19], v[8:11], 0
    v_exp_f32 v42, v42
    v_exp_f32 v43, v43
    v_exp_f32 v44, v44
    v_exp_f32 v45, v45
    s_waitcnt lgkmcnt(0)
    v_smfmac_f32_32x32x32_bf16 v[68:83], v[20:23], v[36:43], v84
    ds_read_b128 v[12:15], v4 offset:24576
    v_exp_f32 v46, v46
    v_exp_f32 v47, v47
    s_mov_b64 exec, s[54:55]
    ds_read_b128 v[28:31], v5 offset:21504
    ds_read_b128 v[32:35], v5 offset:22016
    s_mov_b64 exec, -1
    v_exp_f32 v48, v48
    v_exp_f32 v49, v49
    v_exp_f32 v50, v50
    v_exp_f32 v51, v51
    s_mov_b32 exec_lo, 0x7fc0000
    s_mov_b32 exec_hi, 0x0
    buffer_load_dword v252, v251, s[28:31], 0 offen
    s_mov_b64 exec, -1
    s_setprio 1
    v_exp_f32 v52, v52
    v_exp_f32 v53, v53
    v_smfmac_f32_32x32x32_bf16 v[68:83], v[24:27], v[44:51], v84
    s_waitcnt lgkmcnt(2)
    v_exp_f32 v54, v54
    v_exp_f32 v55, v55
    v_exp_f32 v56, v56
    v_exp_f32 v57, v57
    v_mfma_f32_32x32x16_bf16 v[36:51], v[12:15], v[8:11], 0
    v_exp_f32 v58, v58
    v_exp_f32 v59, v59
    v_exp_f32 v60, v60
    v_exp_f32 v61, v61
    s_waitcnt lgkmcnt(0)
    v_smfmac_f32_32x32x32_bf16 v[68:83], v[28:31], v[52:59], v84
    ds_read_b128 v[16:19], v4 offset:28672
    v_exp_f32 v62, v62
    v_exp_f32 v63, v63
    s_mov_b64 exec, s[54:55]
    ds_read_b128 v[20:23], v5 offset:25600
    ds_read_b128 v[24:27], v5 offset:26112
    s_mov_b64 exec, -1
    v_exp_f32 v64, v64
    v_exp_f32 v65, v65
    v_exp_f32 v66, v66
    v_exp_f32 v67, v67
    s_mov_b32 m0, s37
    s_add_u32 s37, s37, 8192
    buffer_load_dwordx4 v3, s[16:19], s49 offen lds
    s_add_u32 s49, s49, 65536
    s_setprio 0
    v_exp_f32 v36, v36
    v_exp_f32 v37, v37
    v_smfmac_f32_32x32x32_bf16 v[68:83], v[32:35], v[60:67], v84
    s_waitcnt lgkmcnt(2)
    v_exp_f32 v38, v38
    v_exp_f32 v39, v39
    v_exp_f32 v40, v40
    v_exp_f32 v41, v41
    v_mfma_f32_32x32x16_bf16 v[52:67], v[16:19], v[8:11], 0
    v_exp_f32 v42, v42
    v_exp_f32 v43, v43
    v_exp_f32 v44, v44
    v_exp_f32 v45, v45
    s_waitcnt lgkmcnt(0)
    v_smfmac_f32_32x32x32_bf16 v[68:83], v[20:23], v[36:43], v84
    s_waitcnt vmcnt(2)
    s_barrier
    ds_read_b128 v[12:15], v4 offset:32768
    v_exp_f32 v46, v46
    v_exp_f32 v47, v47
    s_mov_b64 exec, s[54:55]
    ds_read_b128 v[28:31], v5 offset:29696
    ds_read_b128 v[32:35], v5 offset:30208
    s_mov_b64 exec, -1
    v_exp_f32 v48, v48
    v_exp_f32 v49, v49
    v_exp_f32 v50, v50
    v_exp_f32 v51, v51
    s_add_u32 s51, s51, 16384
    s_and_b32 s51, s51, 0x3ffff
    s_add_u32 s56, s51, s52
    s_add_u32 m0, s53, 0
    s_nop 0
    buffer_load_dwordx4 v2, s[4:7], s56 offen sc1 lds
    s_setprio 3
    v_exp_f32 v52, v52
    v_exp_f32 v53, v53
    v_smfmac_f32_32x32x32_bf16 v[68:83], v[24:27], v[44:51], v84
    s_waitcnt lgkmcnt(2)
    v_exp_f32 v54, v54
    v_exp_f32 v55, v55
    v_exp_f32 v56, v56
    v_exp_f32 v57, v57
    v_mfma_f32_32x32x16_bf16 v[36:51], v[12:15], v[8:11], 0
    v_exp_f32 v58, v58
    v_exp_f32 v59, v59
    v_exp_f32 v60, v60
    v_exp_f32 v61, v61
    s_waitcnt lgkmcnt(0)
    v_smfmac_f32_32x32x32_bf16 v[68:83], v[28:31], v[52:59], v84
    ds_read_b128 v[16:19], v4 offset:36864
    v_exp_f32 v62, v62
    v_exp_f32 v63, v63
    s_mov_b64 exec, s[54:55]
    ds_read_b128 v[20:23], v5 offset:33792
    ds_read_b128 v[24:27], v5 offset:34304
    s_mov_b64 exec, -1
    v_exp_f32 v64, v64
    v_exp_f32 v65, v65
    v_exp_f32 v66, v66
    v_exp_f32 v67, v67
    s_add_u32 m0, s53, 0
    s_nop 0
    buffer_load_dwordx4 v2, s[4:7], s56 offen offset:1024 sc1 lds
    s_setprio 2
    v_exp_f32 v36, v36
    v_exp_f32 v37, v37
    v_smfmac_f32_32x32x32_bf16 v[68:83], v[32:35], v[60:67], v84
    s_waitcnt lgkmcnt(2)
    v_exp_f32 v38, v38
    v_exp_f32 v39, v39
    v_exp_f32 v40, v40
    v_exp_f32 v41, v41
    v_mfma_f32_32x32x16_bf16 v[52:67], v[16:19], v[8:11], 0
    v_exp_f32 v42, v42
    v_exp_f32 v43, v43
    v_exp_f32 v44, v44
    v_exp_f32 v45, v45
    s_waitcnt lgkmcnt(0)
    v_smfmac_f32_32x32x32_bf16 v[68:83], v[20:23], v[36:43], v84
    ds_read_b128 v[12:15], v4 offset:40960
    v_exp_f32 v46, v46
    v_exp_f32 v47, v47
    s_mov_b64 exec, s[54:55]
    ds_read_b128 v[28:31], v5 offset:37888
    ds_read_b128 v[32:35], v5 offset:38400
    s_mov_b64 exec, -1
    v_exp_f32 v48, v48
    v_exp_f32 v49, v49
    v_exp_f32 v50, v50
    v_exp_f32 v51, v51
    s_mov_b32 exec_lo, 0xf8000000
    s_mov_b32 exec_hi, 0xf
    buffer_load_dword v252, v251, s[28:31], 0 offen
    s_mov_b64 exec, -1
    s_setprio 1
    v_exp_f32 v52, v52
    v_exp_f32 v53, v53
    v_smfmac_f32_32x32x32_bf16 v[68:83], v[24:27], v[44:51], v84
    s_waitcnt lgkmcnt(2)
    v_exp_f32 v54, v54
    v_exp_f32 v55, v55
    v_exp_f32 v56, v56
    v_exp_f32 v57, v57
    v_mfma_f32_32x32x16_bf16 v[36:51], v[12:15], v[8:11], 0
    v_exp_f32 v58, v58
    v_exp_f32 v59, v59
    v_exp_f32 v60, v60
    v_exp_f32 v61, v61
    s_waitcnt lgkmcnt(0)
    v_smfmac_f32_32x32x32_bf16 v[68:83], v[28:31], v[52:59], v84
    ds_read_b128 v[16:19], v4 offset:45056
    v_exp_f32 v62, v62
    v_exp_f32 v63, v63
    s_mov_b64 exec, s[54:55]
    ds_read_b128 v[20:23], v5 offset:41984
    ds_read_b128 v[24:27], v5 offset:42496
    s_mov_b64 exec, -1
    v_exp_f32 v64, v64
    v_exp_f32 v65, v65
    v_exp_f32 v66, v66
    v_exp_f32 v67, v67
    s_mov_b32 m0, s37
    s_add_u32 s37, s37, 8192
    buffer_load_dwordx4 v3, s[16:19], s49 offen lds
    s_add_u32 s49, s49, 65536
    s_setprio 0
    v_exp_f32 v36, v36
    v_exp_f32 v37, v37
    v_smfmac_f32_32x32x32_bf16 v[68:83], v[32:35], v[60:67], v84
    s_waitcnt lgkmcnt(2)
    v_exp_f32 v38, v38
    v_exp_f32 v39, v39
    v_exp_f32 v40, v40
    v_exp_f32 v41, v41
    v_mfma_f32_32x32x16_bf16 v[52:67], v[16:19], v[8:11], 0
    v_exp_f32 v42, v42
    v_exp_f32 v43, v43
    v_exp_f32 v44, v44
    v_exp_f32 v45, v45
    s_waitcnt lgkmcnt(0)
    v_smfmac_f32_32x32x32_bf16 v[68:83], v[20:23], v[36:43], v84
    s_waitcnt vmcnt(2)
    s_barrier
    ds_read_b128 v[12:15], v4 offset:0
    v_exp_f32 v46, v46
    v_exp_f32 v47, v47
    s_mov_b64 exec, s[54:55]
    ds_read_b128 v[28:31], v5 offset:46080
    ds_read_b128 v[32:35], v5 offset:46592
    s_mov_b64 exec, -1
    v_exp_f32 v48, v48
    v_exp_f32 v49, v49
    v_exp_f32 v50, v50
    v_exp_f32 v51, v51
    s_mov_b32 m0, s50
    s_add_u32 s50, s50, 8192
    buffer_load_dwordx4 v250, s[24:27], s48 offen lds
    s_setprio 3
    v_exp_f32 v52, v52
    v_exp_f32 v53, v53
    v_smfmac_f32_32x32x32_bf16 v[68:83], v[24:27], v[44:51], v84
    s_waitcnt lgkmcnt(2)
    v_exp_f32 v54, v54
    v_exp_f32 v55, v55
    v_exp_f32 v56, v56
    v_exp_f32 v57, v57
    v_mfma_f32_32x32x16_bf16 v[36:51], v[12:15], v[8:11], 0
    v_exp_f32 v58, v58
    v_exp_f32 v59, v59
    v_exp_f32 v60, v60
    v_exp_f32 v61, v61
    s_waitcnt lgkmcnt(0)
    v_smfmac_f32_32x32x32_bf16 v[68:83], v[28:31], v[52:59], v84
    ds_read_b128 v[16:19], v4 offset:4096
    v_exp_f32 v62, v62
    v_exp_f32 v63, v63
    s_mov_b64 exec, s[54:55]
    ds_read_b128 v[20:23], v5 offset:1024
    ds_read_b128 v[24:27], v5 offset:1536
    s_mov_b64 exec, -1
    v_exp_f32 v64, v64
    v_exp_f32 v65, v65
    v_exp_f32 v66, v66
    v_exp_f32 v67, v67
    s_add_u32 s48, s48, 352256
    s_mov_b32 m0, s50
    s_add_u32 s50, s50, 8192
    buffer_load_dwordx4 v248, s[24:27], s48 offen lds
    s_setprio 2
    v_exp_f32 v36, v36
    v_exp_f32 v37, v37
    v_smfmac_f32_32x32x32_bf16 v[68:83], v[32:35], v[60:67], v84
    s_waitcnt lgkmcnt(2)
    v_exp_f32 v38, v38
    v_exp_f32 v39, v39
    v_exp_f32 v40, v40
    v_exp_f32 v41, v41
    v_mfma_f32_32x32x16_bf16 v[52:67], v[16:19], v[8:11], 0
    v_exp_f32 v42, v42
    v_exp_f32 v43, v43
    v_exp_f32 v44, v44
    v_exp_f32 v45, v45
    s_waitcnt lgkmcnt(0)
    v_smfmac_f32_32x32x32_bf16 v[68:83], v[20:23], v[36:43], v84
    ds_read_b128 v[12:15], v4 offset:8192
    v_exp_f32 v46, v46
    v_exp_f32 v47, v47
    s_mov_b64 exec, s[54:55]
    ds_read_b128 v[28:31], v5 offset:5120
    ds_read_b128 v[32:35], v5 offset:5632
    s_mov_b64 exec, -1
    v_exp_f32 v48, v48
    v_exp_f32 v49, v49
    v_exp_f32 v50, v50
    v_exp_f32 v51, v51
    s_mov_b32 exec_lo, 0x0
    s_mov_b32 exec_hi, 0x1ff0
    buffer_load_dword v252, v251, s[28:31], 0 offen
    s_mov_b64 exec, -1
    s_setprio 1
    v_exp_f32 v52, v52
    v_exp_f32 v53, v53
    v_smfmac_f32_32x32x32_bf16 v[68:83], v[24:27], v[44:51], v84
    s_waitcnt lgkmcnt(2)
    v_exp_f32 v54, v54
    v_exp_f32 v55, v55
    v_exp_f32 v56, v56
    v_exp_f32 v57, v57
    v_mfma_f32_32x32x16_bf16 v[36:51], v[12:15], v[8:11], 0
    v_exp_f32 v58, v58
    v_exp_f32 v59, v59
    v_exp_f32 v60, v60
    v_exp_f32 v61, v61
    s_waitcnt lgkmcnt(0)
    v_smfmac_f32_32x32x32_bf16 v[68:83], v[28:31], v[52:59], v84
    ds_read_b128 v[16:19], v4 offset:12288
    v_exp_f32 v62, v62
    v_exp_f32 v63, v63
    s_mov_b64 exec, s[54:55]
    ds_read_b128 v[20:23], v5 offset:9216
    ds_read_b128 v[24:27], v5 offset:9728
    s_mov_b64 exec, -1
    v_exp_f32 v64, v64
    v_exp_f32 v65, v65
    v_exp_f32 v66, v66
    v_exp_f32 v67, v67
    s_setprio 0
    v_exp_f32 v36, v36
    v_exp_f32 v37, v37
    v_smfmac_f32_32x32x32_bf16 v[68:83], v[32:35], v[60:67], v84
    s_waitcnt lgkmcnt(2)
    v_exp_f32 v38, v38
    v_exp_f32 v39, v39
    v_exp_f32 v40, v40
    v_exp_f32 v41, v41
    v_mfma_f32_32x32x16_bf16 v[52:67], v[16:19], v[8:11], 0
    v_exp_f32 v42, v42
    v_exp_f32 v43, v43
    v_exp_f32 v44, v44
    v_exp_f32 v45, v45
    s_waitcnt lgkmcnt(0)
    v_smfmac_f32_32x32x32_bf16 v[68:83], v[20:23], v[36:43], v84
    s_waitcnt vmcnt(3)
    s_barrier
    v_exp_f32 v46, v46
    v_exp_f32 v47, v47
    s_mov_b64 exec, s[54:55]
    ds_read_b128 v[28:31], v5 offset:13312
    ds_read_b128 v[32:35], v5 offset:13824
    s_mov_b64 exec, -1
    v_exp_f32 v48, v48
    v_exp_f32 v49, v49
    v_exp_f32 v50, v50
    v_exp_f32 v51, v51
    s_mov_b32 m0, s50
    s_add_u32 s50, s50, 8192
    buffer_load_dwordx4 v249, s[24:27], s48 offen lds
    s_setprio 3
    v_exp_f32 v52, v52
    v_exp_f32 v53, v53
    v_smfmac_f32_32x32x32_bf16 v[68:83], v[24:27], v[44:51], v84
    v_exp_f32 v54, v54
    v_exp_f32 v55, v55
    v_exp_f32 v56, v56
    v_exp_f32 v57, v57
    v_exp_f32 v58, v58
    v_exp_f32 v59, v59
    v_exp_f32 v60, v60
    v_exp_f32 v61, v61
    s_waitcnt lgkmcnt(0)
    v_smfmac_f32_32x32x32_bf16 v[68:83], v[28:31], v[52:59], v84
    v_exp_f32 v62, v62
    v_exp_f32 v63, v63
    v_exp_f32 v64, v64
    v_exp_f32 v65, v65
    v_exp_f32 v66, v66
    v_exp_f32 v67, v67
    s_mov_b32 m0, s50
    s_add_u32 s50, s50, 8192
    buffer_load_dwordx4 v250, s[24:27], s48 offen lds
    s_nop 1
    v_smfmac_f32_32x32x32_bf16 v[68:83], v[32:35], v[60:67], v84
    s_setprio 0
    s_and_b32 s46, s40, 3
    s_lshl_b32 s47, s43, 2
    s_add_u32 s46, s46, s47
    s_lshr_b32 s47, s40, 2
    s_lshl_b32 s48, s44, 1
    s_add_u32 s47, s47, s48
    s_lshl_b32 s8, s46, 15
    s_lshl_b32 s48, s47, 10
    s_add_u32 s8, s8, s48
    s_add_u32 s8, s8, 4194304
    s_lshl_b32 s51, s46, 7
    s_lshl_b32 s48, s47, 2
    s_add_u32 s51, s51, s48
    s_add_u32 s51, s51, 15761408
    s_add_u32 s46, s42, 1
    v_cmp_eq_u32 vcc, s46, v88
    s_cmp_eq_u64 vcc, -1
    s_cselect_b32 s41, 1, 0
    s_mov_b32 s46, 0x2b800000
    s_mov_b32 s47, 0x53800000
    s_waitcnt lgkmcnt(0)
    s_nop 1
    v_cmp_le_f32 s[48:49], s46, v76
    v_cmp_ge_f32 vcc, s47, v76
    v_add_f32 v7, |v68|, |v69|
    v_add_f32 v7, v7, |v70|
    v_add_f32 v7, v7, |v71|
    v_add_f32 v7, v7, |v72|
    v_add_f32 v7, v7, |v73|
    v_add_f32 v7, v7, |v74|
    v_add_f32 v7, v7, |v75|
    s_and_b64 s[48:49], s[48:49], vcc
    s_mov_b32 s46, 0x7e800000
    v_cmp_ge_f32 vcc, s46, v7
    v_rcp_f32 v6, v76
    s_and_b64 s[48:49], s[48:49], vcc
    s_cmp_eq_u64 s[48:49], -1
    s_cbranch_scc0 .Lb_slow
.Lb_out:
    v_mul_f32 v68, v68, v6
    v_mul_f32 v69, v69, v6
    v_mul_f32 v70, v70, v6
    v_mul_f32 v71, v71, v6
    v_mul_f32 v72, v72, v6
    v_mul_f32 v73, v73, v6
    v_mul_f32 v74, v74, v6
    v_mul_f32 v75, v75, v6
    v_cvt_pk_bf16_f32 v12, v68, v69
    v_cvt_pk_bf16_f32 v13, v70, v71
    v_cvt_pk_bf16_f32 v14, v72, v73
    v_cvt_pk_bf16_f32 v15, v74, v75
    buffer_store_dwordx4 v[12:15], v2, s[4:7], s8 offen sc1
    s_cmp_ge_u32 s40, 4
    s_cbranch_scc1 .Ld
    s_lshr_b32 s57, s40, 1
    v_bfe_u32 v10, v1, 2, 2
    v_lshrrev_b32 v7, 5, v1
    v_lshl_add_u32 v10, v7, 2, v10
    v_lshlrev_b32 v10, 6, v10
    v_bfe_u32 v7, v1, 4, 1
    v_lshl_add_u32 v10, v7, 5, v10
    v_and_b32 v7, 3, v1
    v_lshl_add_u32 v10, v7, 3, v10
    s_mul_i32 s46, s57, 33280
    s_add_u32 s46, s46, 49152
    v_add_u32 v4, s46, v10
    s_mul_i32 s46, s57, 32256
    s_add_u32 s46, s46, 49664
    v_add_u32 v5, s46, v10
    v_permlane32_swap_b32 v240, v242
    v_permlane32_swap_b32 v241, v243
    v_permlane32_swap_b32 v244, v246
    v_permlane32_swap_b32 v245, v247
    ds_read_b64_tr_b16 v[48:49], v4 offset:0
    ds_read_b64_tr_b16 v[50:51], v4 offset:1024
    ds_read_b64_tr_b16 v[52:53], v5 offset:0
    ds_read_b64_tr_b16 v[54:55], v5 offset:1024
    v_lshlrev_b32 v16, 16, v240
    v_and_b32 v17, 0xffff0000, v240
    ds_read_b64_tr_b16 v[56:57], v4 offset:2048
    ds_read_b64_tr_b16 v[58:59], v4 offset:3072
    ds_read_b64_tr_b16 v[60:61], v5 offset:2048
    ds_read_b64_tr_b16 v[62:63], v5 offset:3072
    v_lshlrev_b32 v18, 16, v241
    v_and_b32 v19, 0xffff0000, v241
    ds_read_b64_tr_b16 v[64:65], v4 offset:4096
    ds_read_b64_tr_b16 v[66:67], v4 offset:5120
    ds_read_b64_tr_b16 v[68:69], v5 offset:4096
    ds_read_b64_tr_b16 v[70:71], v5 offset:5120
    v_lshlrev_b32 v20, 16, v242
    v_and_b32 v21, 0xffff0000, v242
    ds_read_b64_tr_b16 v[72:73], v4 offset:6144
    ds_read_b64_tr_b16 v[74:75], v4 offset:7168
    ds_read_b64_tr_b16 v[76:77], v5 offset:6144
    ds_read_b64_tr_b16 v[78:79], v5 offset:7168
    v_lshlrev_b32 v22, 16, v243
    v_and_b32 v23, 0xffff0000, v243
    ds_read_b64_tr_b16 v[80:81], v4 offset:8192
    ds_read_b64_tr_b16 v[82:83], v4 offset:9216
    ds_read_b64_tr_b16 v[84:85], v5 offset:8192
    ds_read_b64_tr_b16 v[86:87], v5 offset:9216
    v_lshlrev_b32 v24, 16, v244
    v_and_b32 v25, 0xffff0000, v244
    ds_read_b64_tr_b16 v[88:89], v4 offset:10240
    ds_read_b64_tr_b16 v[90:91], v4 offset:11264
    ds_read_b64_tr_b16 v[92:93], v5 offset:10240
    ds_read_b64_tr_b16 v[94:95], v5 offset:11264
    v_lshlrev_b32 v26, 16, v245
    v_and_b32 v27, 0xffff0000, v245
    ds_read_b64_tr_b16 v[96:97], v4 offset:12288
    ds_read_b64_tr_b16 v[98:99], v4 offset:13312
    ds_read_b64_tr_b16 v[100:101], v5 offset:12288
    ds_read_b64_tr_b16 v[102:103], v5 offset:13312
    v_lshlrev_b32 v28, 16, v246
    v_and_b32 v29, 0xffff0000, v246
    ds_read_b64_tr_b16 v[104:105], v4 offset:14336
    ds_read_b64_tr_b16 v[106:107], v4 offset:15360
    ds_read_b64_tr_b16 v[108:109], v5 offset:14336
    ds_read_b64_tr_b16 v[110:111], v5 offset:15360
    v_lshlrev_b32 v30, 16, v247
    v_and_b32 v31, 0xffff0000, v247
    ds_read_b64_tr_b16 v[112:113], v4 offset:16384
    ds_read_b64_tr_b16 v[114:115], v4 offset:17408
    ds_read_b64_tr_b16 v[116:117], v5 offset:16384
    ds_read_b64_tr_b16 v[118:119], v5 offset:17408
    ds_read_b64_tr_b16 v[120:121], v4 offset:18432
    ds_read_b64_tr_b16 v[122:123], v4 offset:19456
    ds_read_b64_tr_b16 v[124:125], v5 offset:18432
    ds_read_b64_tr_b16 v[126:127], v5 offset:19456
    ds_read_b64_tr_b16 v[128:129], v4 offset:20480
    ds_read_b64_tr_b16 v[130:131], v4 offset:21504
    ds_read_b64_tr_b16 v[132:133], v5 offset:20480
    ds_read_b64_tr_b16 v[134:135], v5 offset:21504
    ds_read_b64_tr_b16 v[136:137], v4 offset:22528
    ds_read_b64_tr_b16 v[138:139], v4 offset:23552
    ds_read_b64_tr_b16 v[140:141], v5 offset:22528
    ds_read_b64_tr_b16 v[142:143], v5 offset:23552
    ds_read_b64_tr_b16 v[144:145], v4 offset:24576
    ds_read_b64_tr_b16 v[146:147], v4 offset:25600
    ds_read_b64_tr_b16 v[148:149], v5 offset:24576
    ds_read_b64_tr_b16 v[150:151], v5 offset:25600
    ds_read_b64_tr_b16 v[152:153], v4 offset:26624
    ds_read_b64_tr_b16 v[154:155], v4 offset:27648
    ds_read_b64_tr_b16 v[156:157], v5 offset:26624
    ds_read_b64_tr_b16 v[158:159], v5 offset:27648
    ds_read_b64_tr_b16 v[160:161], v4 offset:28672
    ds_read_b64_tr_b16 v[162:163], v4 offset:29696
    ds_read_b64_tr_b16 v[164:165], v5 offset:28672
    ds_read_b64_tr_b16 v[166:167], v5 offset:29696
    ds_read_b64_tr_b16 v[168:169], v4 offset:30720
    ds_read_b64_tr_b16 v[170:171], v4 offset:31744
    ds_read_b64_tr_b16 v[172:173], v5 offset:30720
    ds_read_b64_tr_b16 v[174:175], v5 offset:31744
    s_lshl_b32 s56, s43, 2
    s_lshr_b32 s47, s44, 3
    s_lshl_b32 s47, s47, 1
    s_add_u32 s56, s56, s47
    s_and_b32 s47, s40, 1
    s_add_u32 s56, s56, s47
    v_and_b32 v6, 15, v1
    v_lshlrev_b32 v6, 2, v6
    s_lshl_b32 s49, s56, 7
    s_lshl_b32 s47, s57, 6
    s_add_u32 s49, s49, s47
    s_add_u32 s49, s49, 15761408
    s_lshl_b32 s48, s56, 15
    s_lshl_b32 s47, s57, 14
    s_add_u32 s48, s48, s47
    s_add_u32 s48, s48, 4194304
    s_and_b32 s39, s40, 3
    s_lshl_b32 s38, s39, 13
    s_lshl_b32 s39, s39, 10
    s_and_b32 s46, s44, 7
    s_lshl_b32 s46, s46, 7
    s_add_u32 s38, s38, s46
    s_waitcnt vmcnt(0)
    v_mov_b32 v8, 0
    v_mov_b32 v9, 1
    s_mov_b64 exec, 1
    s_cmp_eq_u32 s41, 0
    s_cbranch_scc1 .Lms_4_s
    buffer_store_dword v9, v8, s[4:7], s51 offen
.Lms_4_b:
    s_mov_b64 exec, -1
    s_waitcnt lgkmcnt(0)
    s_barrier
    s_setprio 2
.Lpoll_5:
    buffer_load_dword v7, v6, s[4:7], s49 offen sc1
    s_sub_u32 s45, s45, 1
    s_cbranch_scc0 .Lpoll_5_w
    s_mov_b32 s45, 0
    s_waitcnt vmcnt(0)
    s_branch .Lpoll_5_x
.Lpoll_5_w:
    s_waitcnt vmcnt(0)
    v_cmp_le_u32 vcc, 1, v7
    s_cmp_eq_u64 vcc, -1
    s_cbranch_scc0 .Lpoll_5
.Lpoll_5_x:
    buffer_load_dwordx4 v[176:179], v2, s[4:7], s48 offen offset:0 sc1
    buffer_load_dwordx4 v[180:183], v2, s[4:7], s48 offen offset:1024 sc1
    buffer_load_dwordx4 v[184:187], v2, s[4:7], s48 offen offset:2048 sc1
    buffer_load_dwordx4 v[188:191], v2, s[4:7], s48 offen offset:3072 sc1
    s_add_u32 s47, s48, 4096
    buffer_load_dwordx4 v[192:195], v2, s[4:7], s47 offen offset:0 sc1
    buffer_load_dwordx4 v[196:199], v2, s[4:7], s47 offen offset:1024 sc1
    buffer_load_dwordx4 v[200:203], v2, s[4:7], s47 offen offset:2048 sc1
    buffer_load_dwordx4 v[204:207], v2, s[4:7], s47 offen offset:3072 sc1
    s_add_u32 s47, s48, 8192
    buffer_load_dwordx4 v[208:211], v2, s[4:7], s47 offen offset:0 sc1
    buffer_load_dwordx4 v[212:215], v2, s[4:7], s47 offen offset:1024 sc1
    buffer_load_dwordx4 v[216:219], v2, s[4:7], s47 offen offset:2048 sc1
    buffer_load_dwordx4 v[220:223], v2, s[4:7], s47 offen offset:3072 sc1
    s_add_u32 s47, s48, 12288
    buffer_load_dwordx4 v[224:227], v2, s[4:7], s47 offen offset:0 sc1
    buffer_load_dwordx4 v[228:231], v2, s[4:7], s47 offen offset:1024 sc1
    buffer_load_dwordx4 v[232:235], v2, s[4:7], s47 offen offset:2048 sc1
    buffer_load_dwordx4 v[236:239], v2, s[4:7], s47 offen offset:3072 sc1
    s_barrier
    s_waitcnt vmcnt(15)
    v_mfma_f32_32x32x16_bf16 v[32:47], v[52:55], v[176:179], 0
    v_mfma_f32_32x32x16_bf16 v[16:31], v[48:51], v[176:179], v[16:31]
    s_waitcnt vmcnt(14)
    v_mfma_f32_32x32x16_bf16 v[32:47], v[60:63], v[180:183], v[32:47]
    v_mfma_f32_32x32x16_bf16 v[16:31], v[56:59], v[180:183], v[16:31]
    s_waitcnt vmcnt(13)
    v_mfma_f32_32x32x16_bf16 v[32:47], v[68:71], v[184:187], v[32:47]
    v_mfma_f32_32x32x16_bf16 v[16:31], v[64:67], v[184:187], v[16:31]
    s_waitcnt vmcnt(12)
    v_mfma_f32_32x32x16_bf16 v[32:47], v[76:79], v[188:191], v[32:47]
    v_mfma_f32_32x32x16_bf16 v[16:31], v[72:75], v[188:191], v[16:31]
    s_waitcnt vmcnt(11)
    v_mfma_f32_32x32x16_bf16 v[32:47], v[84:87], v[192:195], v[32:47]
    v_mfma_f32_32x32x16_bf16 v[16:31], v[80:83], v[192:195], v[16:31]
    s_waitcnt vmcnt(10)
    v_mfma_f32_32x32x16_bf16 v[32:47], v[92:95], v[196:199], v[32:47]
    v_mfma_f32_32x32x16_bf16 v[16:31], v[88:91], v[196:199], v[16:31]
    s_waitcnt vmcnt(9)
    v_mfma_f32_32x32x16_bf16 v[32:47], v[100:103], v[200:203], v[32:47]
    v_mfma_f32_32x32x16_bf16 v[16:31], v[96:99], v[200:203], v[16:31]
    s_waitcnt vmcnt(8)
    v_mfma_f32_32x32x16_bf16 v[32:47], v[108:111], v[204:207], v[32:47]
    v_mfma_f32_32x32x16_bf16 v[16:31], v[104:107], v[204:207], v[16:31]
    s_waitcnt vmcnt(7)
    v_mfma_f32_32x32x16_bf16 v[32:47], v[116:119], v[208:211], v[32:47]
    v_mfma_f32_32x32x16_bf16 v[16:31], v[112:115], v[208:211], v[16:31]
    s_waitcnt vmcnt(6)
    v_mfma_f32_32x32x16_bf16 v[32:47], v[124:127], v[212:215], v[32:47]
    v_mfma_f32_32x32x16_bf16 v[16:31], v[120:123], v[212:215], v[16:31]
    s_waitcnt vmcnt(5)
    v_mfma_f32_32x32x16_bf16 v[32:47], v[132:135], v[216:219], v[32:47]
    v_mfma_f32_32x32x16_bf16 v[16:31], v[128:131], v[216:219], v[16:31]
    s_waitcnt vmcnt(4)
    v_mfma_f32_32x32x16_bf16 v[32:47], v[140:143], v[220:223], v[32:47]
    v_mfma_f32_32x32x16_bf16 v[16:31], v[136:139], v[220:223], v[16:31]
    s_waitcnt vmcnt(3)
    v_mfma_f32_32x32x16_bf16 v[32:47], v[148:151], v[224:227], v[32:47]
    v_mfma_f32_32x32x16_bf16 v[16:31], v[144:147], v[224:227], v[16:31]
    s_waitcnt vmcnt(2)
    v_mfma_f32_32x32x16_bf16 v[32:47], v[156:159], v[228:231], v[32:47]
    v_mfma_f32_32x32x16_bf16 v[16:31], v[152:155], v[228:231], v[16:31]
    s_waitcnt vmcnt(1)
    v_mfma_f32_32x32x16_bf16 v[32:47], v[164:167], v[232:235], v[32:47]
    v_mfma_f32_32x32x16_bf16 v[16:31], v[160:163], v[232:235], v[16:31]
    s_waitcnt vmcnt(0)
    v_mfma_f32_32x32x16_bf16 v[32:47], v[172:175], v[236:239], v[32:47]
    v_mfma_f32_32x32x16_bf16 v[16:31], v[168:171], v[236:239], v[16:31]
    s_lshl_b32 s46, s40, 12
    s_add_u32 s47, s46, 98304
    v_add_u32 v8, s47, v2
    s_xor_b32 s46, s46, 8192
    s_add_u32 s46, s46, 98304
    v_add_u32 v9, s46, v2
    s_nop 4
    ds_write_b128 v8, v[32:35] offset:0
    ds_write_b128 v8, v[36:39] offset:1024
    ds_write_b128 v8, v[40:43] offset:2048
    ds_write_b128 v8, v[44:47] offset:3072
    s_waitcnt lgkmcnt(0)
    s_barrier
    ds_read_b128 v[32:35], v9 offset:0
    ds_read_b128 v[36:39], v9 offset:1024
    ds_read_b128 v[40:43], v9 offset:2048
    ds_read_b128 v[44:47], v9 offset:3072
    s_waitcnt lgkmcnt(3)
    v_add_f32 v16, v16, v32
    v_add_f32 v17, v17, v33
    v_add_f32 v18, v18, v34
    v_add_f32 v19, v19, v35
    s_waitcnt lgkmcnt(2)
    v_add_f32 v20, v20, v36
    v_add_f32 v21, v21, v37
    v_add_f32 v22, v22, v38
    v_add_f32 v23, v23, v39
    s_waitcnt lgkmcnt(1)
    v_add_f32 v24, v24, v40
    v_add_f32 v25, v25, v41
    v_add_f32 v26, v26, v42
    v_add_f32 v27, v27, v43
    s_waitcnt lgkmcnt(0)
    v_add_f32 v28, v28, v44
    v_add_f32 v29, v29, v45
    v_add_f32 v30, v30, v46
    v_add_f32 v31, v31, v47
    v_cvt_pk_bf16_f32 v48, v16, v17
    v_cvt_pk_bf16_f32 v49, v18, v19
    v_cvt_pk_bf16_f32 v50, v20, v21
    v_cvt_pk_bf16_f32 v51, v22, v23
    v_cvt_pk_bf16_f32 v52, v24, v25
    v_cvt_pk_bf16_f32 v53, v26, v27
    v_cvt_pk_bf16_f32 v54, v28, v29
    v_cvt_pk_bf16_f32 v55, v30, v31
    s_and_b32 s47, s44, 7
    s_lshl_b32 s47, s47, 1
    s_add_u32 s47, s47, s57
    s_lshl_b32 s46, s56, 15
    s_lshl_b32 s48, s47, 11
    s_add_u32 s46, s46, s48
    s_add_u32 s46, s46, 6291456
    buffer_store_dwordx4 v[48:51], v2, s[4:7], s46 offen offset:0 sc1
    buffer_store_dwordx4 v[52:55], v2, s[4:7], s46 offen offset:1024 sc1
    v_add_f32 v56, v16, v17
    v_mul_f32 v57, v16, v16
    v_add_f32 v58, v18, v19
    v_mul_f32 v59, v17, v17
    v_fmac_f32 v57, v18, v18
    v_fmac_f32 v59, v19, v19
    v_add_f32 v56, v56, v20
    v_fmac_f32 v57, v20, v20
    v_add_f32 v58, v58, v21
    v_fmac_f32 v59, v21, v21
    v_add_f32 v56, v56, v22
    v_fmac_f32 v57, v22, v22
    v_add_f32 v58, v58, v23
    v_fmac_f32 v59, v23, v23
    v_add_f32 v56, v56, v24
    v_fmac_f32 v57, v24, v24
    v_add_f32 v58, v58, v25
    v_fmac_f32 v59, v25, v25
    v_add_f32 v56, v56, v26
    v_fmac_f32 v57, v26, v26
    v_add_f32 v58, v58, v27
    v_fmac_f32 v59, v27, v27
    v_add_f32 v56, v56, v28
    v_fmac_f32 v57, v28, v28
    v_add_f32 v58, v58, v29
    v_fmac_f32 v59, v29, v29
    v_add_f32 v56, v56, v30
    v_fmac_f32 v57, v30, v30
    v_add_f32 v58, v58, v31
    v_fmac_f32 v59, v31, v31
    v_add_f32 v56, v56, v58
    v_add_f32 v57, v57, v59
    s_lshl_b32 s46, s56, 12
    s_lshl_b32 s48, s47, 8
    s_add_u32 s46, s46, s48
    s_add_u32 s46, s46, 14680064
    v_permlane32_swap_b32 v56, v57
    v_lshlrev_b32 v8, 2, v1
    v_add_f32 v56, v56, v57
    buffer_store_dword v56, v8, s[4:7], s46 offen sc1
    s_barrier
    s_mul_i32 s46, s57, 2560
    v_add_u32 v4, s46, v10
    s_mul_i32 s46, s57, 1536
    s_add_u32 s46, s46, 512
    v_add_u32 v5, s46, v10
    v_add_u32 v11, 65536, v4
    v_add_u32 v12, 65536, v5
    s_lshl_b32 s46, s56, 7
    s_lshl_b32 s48, s47, 2
    s_add_u32 s51, s46, s48
    s_add_u32 s51, s51, 15769600
    v_add_u32 v13, 131072, v4
    v_add_u32 v14, 131072, v5
    s_lshl_b32 s49, s56, 7
    s_add_u32 s49, s49, 15777792
    s_mul_i32 s48, s56, 88064
    s_lshl_b32 s47, s57, 10
    s_add_u32 s48, s48, s47
    s_add_u32 s48, s48, 8388608
    ds_read_b64_tr_b16 v[64:65], v4 offset:49152
    ds_read_b64_tr_b16 v[66:67], v4 offset:50176
    ds_read_b64_tr_b16 v[68:69], v5 offset:49152
    ds_read_b64_tr_b16 v[70:71], v5 offset:50176
    ds_read_b64_tr_b16 v[72:73], v4 offset:53248
    ds_read_b64_tr_b16 v[74:75], v4 offset:54272
    ds_read_b64_tr_b16 v[76:77], v5 offset:53248
    ds_read_b64_tr_b16 v[78:79], v5 offset:54272
    ds_read_b64_tr_b16 v[80:81], v4 offset:57344
    ds_read_b64_tr_b16 v[82:83], v4 offset:58368
    ds_read_b64_tr_b16 v[84:85], v5 offset:57344
    ds_read_b64_tr_b16 v[86:87], v5 offset:58368
    ds_read_b64_tr_b16 v[88:89], v4 offset:61440
    ds_read_b64_tr_b16 v[90:91], v4 offset:62464
    ds_read_b64_tr_b16 v[92:93], v5 offset:61440
    ds_read_b64_tr_b16 v[94:95], v5 offset:62464
    ds_read_b64_tr_b16 v[96:97], v11 offset:0
    ds_read_b64_tr_b16 v[98:99], v11 offset:1024
    ds_read_b64_tr_b16 v[100:101], v12 offset:0
    ds_read_b64_tr_b16 v[102:103], v12 offset:1024
    ds_read_b64_tr_b16 v[104:105], v11 offset:4096
    ds_read_b64_tr_b16 v[106:107], v11 offset:5120
    ds_read_b64_tr_b16 v[108:109], v12 offset:4096
    ds_read_b64_tr_b16 v[110:111], v12 offset:5120
    ds_read_b64_tr_b16 v[112:113], v11 offset:8192
    ds_read_b64_tr_b16 v[114:115], v11 offset:9216
    ds_read_b64_tr_b16 v[116:117], v12 offset:8192
    ds_read_b64_tr_b16 v[118:119], v12 offset:9216
    ds_read_b64_tr_b16 v[120:121], v11 offset:12288
    ds_read_b64_tr_b16 v[122:123], v11 offset:13312
    ds_read_b64_tr_b16 v[124:125], v12 offset:12288
    ds_read_b64_tr_b16 v[126:127], v12 offset:13312
    ds_read_b64_tr_b16 v[128:129], v11 offset:16384
    ds_read_b64_tr_b16 v[130:131], v11 offset:17408
    ds_read_b64_tr_b16 v[132:133], v12 offset:16384
    ds_read_b64_tr_b16 v[134:135], v12 offset:17408
    ds_read_b64_tr_b16 v[136:137], v11 offset:20480
    ds_read_b64_tr_b16 v[138:139], v11 offset:21504
    ds_read_b64_tr_b16 v[140:141], v12 offset:20480
    ds_read_b64_tr_b16 v[142:143], v12 offset:21504
    ds_read_b64_tr_b16 v[144:145], v11 offset:24576
    ds_read_b64_tr_b16 v[146:147], v11 offset:25600
    ds_read_b64_tr_b16 v[148:149], v12 offset:24576
    ds_read_b64_tr_b16 v[150:151], v12 offset:25600
    s_waitcnt lgkmcnt(0)
    s_barrier
    s_waitcnt vmcnt(0)
    v_mov_b32 v8, 0
    v_mov_b32 v9, 1
    s_mov_b64 exec, 1
    s_cmp_eq_u32 s41, 0
    s_cbranch_scc1 .Lms_6_s
    buffer_store_dword v9, v8, s[4:7], s51 offen
.Lms_6_b:
    s_mov_b64 exec, -1
    s_setprio 0
    s_add_u32 m0, s39, 49152
    s_add_u32 s47, s38, 131072
    buffer_load_dwordx4 v3, s[28:31], s47 offen lds
    s_add_u32 m0, s39, 53248
    s_add_u32 s47, s38, 229376
    buffer_load_dwordx4 v3, s[28:31], s47 offen lds
    s_waitcnt vmcnt(1)
    s_add_u32 m0, s39, 57344
    s_add_u32 s47, s38, 327680
    buffer_load_dwordx4 v3, s[28:31], s47 offen lds
    s_waitcnt vmcnt(1)
    s_add_u32 m0, s39, 61440
    s_add_u32 s47, s38, 425984
    buffer_load_dwordx4 v3, s[28:31], s47 offen lds
    s_waitcnt vmcnt(1)
    s_add_u32 m0, s39, 65536
    s_add_u32 s47, s38, 524288
    buffer_load_dwordx4 v3, s[28:31], s47 offen lds
    s_waitcnt vmcnt(1)
    s_add_u32 m0, s39, 69632
    s_add_u32 s47, s38, 622592
    buffer_load_dwordx4 v3, s[28:31], s47 offen lds
    s_barrier
    s_add_u32 m0, s39, 73728
    s_add_u32 s47, s38, 720896
    buffer_load_dwordx4 v3, s[28:31], s47 offen lds
    s_add_u32 m0, s39, 77824
    s_add_u32 s47, s38, 819200
    buffer_load_dwordx4 v3, s[28:31], s47 offen lds
    s_add_u32 m0, s39, 81920
    s_add_u32 s47, s38, 917504
    buffer_load_dwordx4 v3, s[28:31], s47 offen lds
    s_add_u32 m0, s39, 86016
    s_add_u32 s47, s38, 1015808
    buffer_load_dwordx4 v3, s[28:31], s47 offen lds
    s_add_u32 m0, s39, 90112
    s_add_u32 s47, s38, 1114112
    buffer_load_dwordx4 v3, s[28:31], s47 offen lds
    s_add_u32 m0, s39, 114688
    s_add_u32 s47, s38, 1212416
    buffer_load_dwordx4 v3, s[28:31], s47 offen lds
    s_add_u32 m0, s39, 118784
    s_add_u32 s47, s38, 1310720
    buffer_load_dwordx4 v3, s[28:31], s47 offen lds
    s_add_u32 m0, s39, 122880
    s_add_u32 s47, s38, 65536
    buffer_load_dwordx4 v3, s[28:31], s47 offen lds
    s_add_u32 m0, s39, 126976
    s_add_u32 s47, s38, 163840
    buffer_load_dwordx4 v3, s[28:31], s47 offen lds
    s_add_u32 m0, s39, 131072
    s_add_u32 s47, s38, 262144
    buffer_load_dwordx4 v3, s[28:31], s47 offen lds
    s_add_u32 m0, s39, 135168
    s_add_u32 s47, s38, 360448
    buffer_load_dwordx4 v3, s[28:31], s47 offen lds
    s_add_u32 m0, s39, 139264
    s_add_u32 s47, s38, 458752
    buffer_load_dwordx4 v3, s[28:31], s47 offen lds
    s_add_u32 m0, s39, 143360
    s_add_u32 s47, s38, 557056
    buffer_load_dwordx4 v3, s[28:31], s47 offen lds
    s_add_u32 m0, s39, 147456
    s_add_u32 s47, s38, 655360
    buffer_load_dwordx4 v3, s[28:31], s47 offen lds
    s_add_u32 m0, s39, 151552
    s_add_u32 s47, s38, 753664
    buffer_load_dwordx4 v3, s[28:31], s47 offen lds
    s_add_u32 m0, s39, 155648
    s_add_u32 s47, s38, 851968
    buffer_load_dwordx4 v3, s[28:31], s47 offen lds
    s_add_u32 m0, s39, 159744
    s_add_u32 s47, s38, 950272
    buffer_load_dwordx4 v3, s[28:31], s47 offen lds
    s_add_u32 m0, s39, 0
    s_add_u32 s47, s38, 1048576
    buffer_load_dwordx4 v3, s[28:31], s47 offen lds
    s_add_u32 m0, s39, 4096
    s_add_u32 s47, s38, 1146880
    buffer_load_dwordx4 v3, s[28:31], s47 offen lds
    s_add_u32 m0, s39, 8192
    s_add_u32 s47, s38, 1245184
    buffer_load_dwordx4 v3, s[28:31], s47 offen lds
    s_add_u32 m0, s39, 12288
    s_add_u32 s47, s38, 1343488
    buffer_load_dwordx4 v3, s[28:31], s47 offen lds
    s_and_b32 s46, s40, 1
    s_lshl_b32 s46, s46, 13
    s_add_u32 s46, s46, 16384
    s_mul_i32 s47, s57, 16384
    s_add_u32 s47, s47, s46
    v_and_b32 v199, 31, v1
    v_and_b32 v200, 7, v199
    v_bfe_u32 v198, v199, 1, 1
    v_lshl_or_b32 v200, v198, 3, v200
    v_lshrrev_b32 v198, 5, v1
    v_lshlrev_b32 v198, 3, v198
    v_xor_b32 v200, v200, v198
    v_lshlrev_b32 v200, 4, v200
    v_lshl_add_u32 v200, v199, 8, v200
    v_add_u32 v200, s47, v200
    s_lshl_b32 s47, s57, 6
    v_xor_b32 v200, s47, v200
    v_xor_b32 v201, 16, v200
    v_xor_b32 v202, 32, v200
    v_xor_b32 v203, 48, v200
    v_xor_b32 v204, 64, v200
    v_xor_b32 v205, 80, v200
    v_xor_b32 v206, 96, v200
    v_xor_b32 v207, 112, v200
    s_lshl_b32 s47, s57, 12
    s_add_u32 s46, s46, s47
    v_lshrrev_b32 v199, 3, v1
    v_and_b32 v208, 7, v199
    v_bfe_u32 v198, v199, 1, 1
    v_lshl_or_b32 v208, v198, 3, v208
    v_and_b32 v211, 7, v1
    v_xor_b32 v208, v208, v211
    v_lshlrev_b32 v208, 4, v208
    v_lshl_add_u32 v208, v199, 8, v208
    v_add_u32 v208, s46, v208
    v_xor_b32 v209, 0x80, v208
    s_lshl_b32 s46, s56, 15
    s_and_b32 s47, s44, 7
    s_lshl_b32 s47, s47, 7
    s_add_u32 s46, s46, s47
    s_lshl_b32 s47, s57, 14
    s_add_u32 s46, s46, s47
    v_lshlrev_b32 v210, 10, v199
    v_lshl_add_u32 v210, v211, 4, v210
    v_add_u32 v210, s46, v210
    v_add_u32 v211, 8192, v210
    s_setprio 2
.Lpoll_7:
    buffer_load_dword v7, v6, s[4:7], s49 offen sc1
    s_sub_u32 s45, s45, 1
    s_cbranch_scc0 .Lpoll_7_w
    s_mov_b32 s45, 0
    s_waitcnt vmcnt(0)
    s_branch .Lpoll_7_x
.Lpoll_7_w:
    s_waitcnt vmcnt(0)
    v_cmp_le_u32 vcc, 1, v7
    s_cmp_eq_u64 vcc, -1
    s_cbranch_scc0 .Lpoll_7
.Lpoll_7_x:
    s_add_u32 s47, s48, 0
    buffer_load_dwordx4 v[152:155], v2, s[4:7], s47 offen sc1
    s_add_u32 s47, s48, 6144
    buffer_load_dwordx4 v[156:159], v2, s[4:7], s47 offen sc1
    s_add_u32 s47, s48, 12288
    buffer_load_dwordx4 v[160:163], v2, s[4:7], s47 offen sc1
    s_add_u32 s47, s48, 18432
    buffer_load_dwordx4 v[164:167], v2, s[4:7], s47 offen sc1
    s_add_u32 s47, s48, 24576
    buffer_load_dwordx4 v[168:171], v2, s[4:7], s47 offen sc1
    s_add_u32 s47, s48, 30720
    buffer_load_dwordx4 v[172:175], v2, s[4:7], s47 offen sc1
    s_add_u32 s47, s48, 36864
    buffer_load_dwordx4 v[176:179], v2, s[4:7], s47 offen sc1
    s_add_u32 s47, s48, 43008
    buffer_load_dwordx4 v[180:183], v2, s[4:7], s47 offen sc1
    s_add_u32 s47, s48, 49152
    buffer_load_dwordx4 v[184:187], v2, s[4:7], s47 offen sc1
    s_waitcnt vmcnt(8)
    v_mfma_f32_32x32x16_bf16 v[32:47], v[68:71], v[152:155], 0
    v_mfma_f32_32x32x16_bf16 v[16:31], v[64:67], v[152:155], v[16:31]
    s_add_u32 s47, s48, 55296
    buffer_load_dwordx4 v[188:191], v2, s[4:7], s47 offen sc1
    s_waitcnt vmcnt(8)
    v_mfma_f32_32x32x16_bf16 v[32:47], v[76:79], v[156:159], v[32:47]
    v_mfma_f32_32x32x16_bf16 v[16:31], v[72:75], v[156:159], v[16:31]
    s_add_u32 s47, s48, 61440
    buffer_load_dwordx4 v[152:155], v2, s[4:7], s47 offen sc1
    s_waitcnt vmcnt(8)
    v_mfma_f32_32x32x16_bf16 v[32:47], v[84:87], v[160:163], v[32:47]
    v_mfma_f32_32x32x16_bf16 v[16:31], v[80:83], v[160:163], v[16:31]
    s_add_u32 s47, s48, 67584
    buffer_load_dwordx4 v[156:159], v2, s[4:7], s47 offen sc1
    s_waitcnt vmcnt(8)
    v_mfma_f32_32x32x16_bf16 v[32:47], v[92:95], v[164:167], v[32:47]
    v_mfma_f32_32x32x16_bf16 v[16:31], v[88:91], v[164:167], v[16:31]
    s_add_u32 s47, s48, 73728
    buffer_load_dwordx4 v[160:163], v2, s[4:7], s47 offen sc1
    s_waitcnt vmcnt(8)
    v_mfma_f32_32x32x16_bf16 v[32:47], v[100:103], v[168:171], v[32:47]
    v_mfma_f32_32x32x16_bf16 v[16:31], v[96:99], v[168:171], v[16:31]
    s_add_u32 s47, s48, 79872
    buffer_load_dwordx4 v[164:167], v2, s[4:7], s47 offen sc1
    s_waitcnt vmcnt(8)
    v_mfma_f32_32x32x16_bf16 v[32:47], v[108:111], v[172:175], v[32:47]
    v_mfma_f32_32x32x16_bf16 v[16:31], v[104:107], v[172:175], v[16:31]
    s_add_u32 s47, s48, 86016
    buffer_load_dwordx4 v[168:171], v2, s[4:7], s47 offen sc1
    s_waitcnt vmcnt(8)
    v_mfma_f32_32x32x16_bf16 v[32:47], v[116:119], v[176:179], v[32:47]
    v_mfma_f32_32x32x16_bf16 v[16:31], v[112:115], v[176:179], v[16:31]
    s_waitcnt vmcnt(7)
    v_mfma_f32_32x32x16_bf16 v[32:47], v[124:127], v[180:183], v[32:47]
    v_mfma_f32_32x32x16_bf16 v[16:31], v[120:123], v[180:183], v[16:31]
    s_waitcnt vmcnt(6)
    v_mfma_f32_32x32x16_bf16 v[32:47], v[132:135], v[184:187], v[32:47]
    v_mfma_f32_32x32x16_bf16 v[16:31], v[128:131], v[184:187], v[16:31]
    s_barrier
    s_add_u32 s47, s48, 2048
    buffer_load_dwordx4 v[172:175], v2, s[4:7], s47 offen sc1
    s_add_u32 s47, s48, 8192
    buffer_load_dwordx4 v[176:179], v2, s[4:7], s47 offen sc1
    s_add_u32 s47, s48, 14336
    buffer_load_dwordx4 v[180:183], v2, s[4:7], s47 offen sc1
    s_waitcnt vmcnt(8)
    v_mfma_f32_32x32x16_bf16 v[32:47], v[140:143], v[188:191], v[32:47]
    ds_read_b64_tr_b16 v[244:245], v11 offset:28672
    ds_read_b64_tr_b16 v[246:247], v11 offset:29696
    ds_read_b64_tr_b16 v[248:249], v12 offset:28672
    ds_read_b64_tr_b16 v[250:251], v12 offset:29696
    v_mfma_f32_32x32x16_bf16 v[16:31], v[136:139], v[188:191], v[16:31]
    s_add_u32 s47, s48, 20480
    buffer_load_dwordx4 v[184:187], v2, s[4:7], s47 offen sc1
    s_waitcnt vmcnt(8)
    v_mfma_f32_32x32x16_bf16 v[32:47], v[148:151], v[152:155], v[32:47]
    ds_read_b64_tr_b16 v[48:49], v11 offset:32768
    ds_read_b64_tr_b16 v[50:51], v11 offset:33792
    ds_read_b64_tr_b16 v[52:53], v12 offset:32768
    ds_read_b64_tr_b16 v[54:55], v12 offset:33792
    v_mfma_f32_32x32x16_bf16 v[16:31], v[144:147], v[152:155], v[16:31]
    s_add_u32 s47, s48, 26624
    buffer_load_dwordx4 v[188:191], v2, s[4:7], s47 offen sc1
    s_waitcnt vmcnt(8) lgkmcnt(4)
    v_mfma_f32_32x32x16_bf16 v[32:47], v[248:251], v[156:159], v[32:47]
    ds_read_b64_tr_b16 v[56:57], v11 offset:36864
    ds_read_b64_tr_b16 v[58:59], v11 offset:37888
    ds_read_b64_tr_b16 v[60:61], v12 offset:36864
    ds_read_b64_tr_b16 v[62:63], v12 offset:37888
    v_mfma_f32_32x32x16_bf16 v[16:31], v[244:247], v[156:159], v[16:31]
    s_add_u32 s47, s48, 32768
    buffer_load_dwordx4 v[152:155], v2, s[4:7], s47 offen sc1
    s_waitcnt vmcnt(8) lgkmcnt(4)
    v_mfma_f32_32x32x16_bf16 v[32:47], v[52:55], v[160:163], v[32:47]
    ds_read_b64_tr_b16 v[244:245], v11 offset:40960
    ds_read_b64_tr_b16 v[246:247], v11 offset:41984
    ds_read_b64_tr_b16 v[248:249], v12 offset:40960
    ds_read_b64_tr_b16 v[250:251], v12 offset:41984
    v_mfma_f32_32x32x16_bf16 v[16:31], v[48:51], v[160:163], v[16:31]
    s_add_u32 s47, s48, 38912
    buffer_load_dwordx4 v[156:159], v2, s[4:7], s47 offen sc1
    s_waitcnt vmcnt(8) lgkmcnt(4)
    v_mfma_f32_32x32x16_bf16 v[32:47], v[60:63], v[164:167], v[32:47]
    ds_read_b64_tr_b16 v[48:49], v11 offset:45056
    ds_read_b64_tr_b16 v[50:51], v11 offset:46080
    ds_read_b64_tr_b16 v[52:53], v12 offset:45056
    ds_read_b64_tr_b16 v[54:55], v12 offset:46080
    v_mfma_f32_32x32x16_bf16 v[16:31], v[56:59], v[164:167], v[16:31]
    s_add_u32 s47, s48, 45056
    buffer_load_dwordx4 v[160:163], v2, s[4:7], s47 offen sc1
    s_waitcnt vmcnt(8) lgkmcnt(4)
    v_mfma_f32_32x32x16_bf16 v[32:47], v[248:251], v[168:171], v[32:47]
    ds_read_b64_tr_b16 v[56:57], v4 offset:49152
    ds_read_b64_tr_b16 v[58:59], v4 offset:50176
    ds_read_b64_tr_b16 v[60:61], v5 offset:49152
    ds_read_b64_tr_b16 v[62:63], v5 offset:50176
    v_mfma_f32_32x32x16_bf16 v[16:31], v[244:247], v[168:171], v[16:31]
    s_add_u32 s47, s48, 51200
    buffer_load_dwordx4 v[164:167], v2, s[4:7], s47 offen sc1
    s_waitcnt vmcnt(8) lgkmcnt(4)
    v_mfma_f32_32x32x16_bf16 v[32:47], v[52:55], v[172:175], v[32:47]
    ds_read_b64_tr_b16 v[244:245], v4 offset:53248
    ds_read_b64_tr_b16 v[246:247], v4 offset:54272
    ds_read_b64_tr_b16 v[248:249], v5 offset:53248
    ds_read_b64_tr_b16 v[250:251], v5 offset:54272
    v_mfma_f32_32x32x16_bf16 v[16:31], v[48:51], v[172:175], v[16:31]
    s_add_u32 s47, s48, 57344
    buffer_load_dwordx4 v[168:171], v2, s[4:7], s47 offen sc1
    s_waitcnt vmcnt(8) lgkmcnt(4)
    v_mfma_f32_32x32x16_bf16 v[32:47], v[60:63], v[176:179], v[32:47]
    ds_read_b64_tr_b16 v[48:49], v4 offset:57344
    ds_read_b64_tr_b16 v[50:51], v4 offset:58368
    ds_read_b64_tr_b16 v[52:53], v5 offset:57344
    ds_read_b64_tr_b16 v[54:55], v5 offset:58368
    v_mfma_f32_32x32x16_bf16 v[16:31], v[56:59], v[176:179], v[16:31]
    s_add_u32 s47, s48, 63488
    buffer_load_dwordx4 v[172:175], v2, s[4:7], s47 offen sc1
    s_waitcnt vmcnt(8) lgkmcnt(4)
    v_mfma_f32_32x32x16_bf16 v[32:47], v[248:251], v[180:183], v[32:47]
    ds_read_b64_tr_b16 v[56:57], v4 offset:61440
    ds_read_b64_tr_b16 v[58:59], v4 offset:62464
    ds_read_b64_tr_b16 v[60:61], v5 offset:61440
    ds_read_b64_tr_b16 v[62:63], v5 offset:62464
    v_mfma_f32_32x32x16_bf16 v[16:31], v[244:247], v[180:183], v[16:31]
    s_add_u32 s47, s48, 69632
    buffer_load_dwordx4 v[176:179], v2, s[4:7], s47 offen sc1
    s_waitcnt vmcnt(8) lgkmcnt(4)
    v_mfma_f32_32x32x16_bf16 v[32:47], v[52:55], v[184:187], v[32:47]
    ds_read_b64_tr_b16 v[244:245], v11 offset:0
    ds_read_b64_tr_b16 v[246:247], v11 offset:1024
    ds_read_b64_tr_b16 v[248:249], v12 offset:0
    ds_read_b64_tr_b16 v[250:251], v12 offset:1024
    v_mfma_f32_32x32x16_bf16 v[16:31], v[48:51], v[184:187], v[16:31]
    s_add_u32 s47, s48, 75776
    buffer_load_dwordx4 v[180:183], v2, s[4:7], s47 offen sc1
    s_waitcnt vmcnt(8) lgkmcnt(4)
    v_mfma_f32_32x32x16_bf16 v[32:47], v[60:63], v[188:191], v[32:47]
    ds_read_b64_tr_b16 v[48:49], v11 offset:4096
    ds_read_b64_tr_b16 v[50:51], v11 offset:5120
    ds_read_b64_tr_b16 v[52:53], v12 offset:4096
    ds_read_b64_tr_b16 v[54:55], v12 offset:5120
    v_mfma_f32_32x32x16_bf16 v[16:31], v[56:59], v[188:191], v[16:31]
    s_add_u32 s47, s48, 81920
    buffer_load_dwordx4 v[184:187], v2, s[4:7], s47 offen sc1
    s_waitcnt vmcnt(8) lgkmcnt(4)
    v_mfma_f32_32x32x16_bf16 v[32:47], v[248:251], v[152:155], v[32:47]
    ds_read_b64_tr_b16 v[56:57], v11 offset:8192
    ds_read_b64_tr_b16 v[58:59], v11 offset:9216
    ds_read_b64_tr_b16 v[60:61], v12 offset:8192
    ds_read_b64_tr_b16 v[62:63], v12 offset:9216
    v_mfma_f32_32x32x16_bf16 v[16:31], v[244:247], v[152:155], v[16:31]
    s_barrier
    s_add_u32 s47, s48, 4096
    buffer_load_dwordx4 v[188:191], v2, s[4:7], s47 offen sc1
    s_waitcnt vmcnt(8) lgkmcnt(4)
    v_mfma_f32_32x32x16_bf16 v[32:47], v[52:55], v[156:159], v[32:47]
    ds_read_b64_tr_b16 v[244:245], v11 offset:12288
    ds_read_b64_tr_b16 v[246:247], v11 offset:13312
    ds_read_b64_tr_b16 v[248:249], v12 offset:12288
    ds_read_b64_tr_b16 v[250:251], v12 offset:13312
    v_mfma_f32_32x32x16_bf16 v[16:31], v[48:51], v[156:159], v[16:31]
    s_add_u32 s47, s48, 10240
    buffer_load_dwordx4 v[152:155], v2, s[4:7], s47 offen sc1
    s_waitcnt vmcnt(8) lgkmcnt(4)
    v_mfma_f32_32x32x16_bf16 v[32:47], v[60:63], v[160:163], v[32:47]
    ds_read_b64_tr_b16 v[48:49], v11 offset:16384
    ds_read_b64_tr_b16 v[50:51], v11 offset:17408
    ds_read_b64_tr_b16 v[52:53], v12 offset:16384
    ds_read_b64_tr_b16 v[54:55], v12 offset:17408
    v_mfma_f32_32x32x16_bf16 v[16:31], v[56:59], v[160:163], v[16:31]
    s_add_u32 s47, s48, 16384
    buffer_load_dwordx4 v[156:159], v2, s[4:7], s47 offen sc1
    s_waitcnt vmcnt(8) lgkmcnt(4)
    v_mfma_f32_32x32x16_bf16 v[32:47], v[248:251], v[164:167], v[32:47]
    ds_read_b64_tr_b16 v[56:57], v11 offset:20480
    ds_read_b64_tr_b16 v[58:59], v11 offset:21504
    ds_read_b64_tr_b16 v[60:61], v12 offset:20480
    ds_read_b64_tr_b16 v[62:63], v12 offset:21504
    v_mfma_f32_32x32x16_bf16 v[16:31], v[244:247], v[164:167], v[16:31]
    s_add_u32 s47, s48, 22528
    buffer_load_dwordx4 v[160:163], v2, s[4:7], s47 offen sc1
    s_waitcnt vmcnt(8) lgkmcnt(4)
    v_mfma_f32_32x32x16_bf16 v[32:47], v[52:55], v[168:171], v[32:47]
    ds_read_b64_tr_b16 v[244:245], v11 offset:24576
    ds_read_b64_tr_b16 v[246:247], v11 offset:25600
    ds_read_b64_tr_b16 v[248:249], v12 offset:24576
    ds_read_b64_tr_b16 v[250:251], v12 offset:25600
    v_mfma_f32_32x32x16_bf16 v[16:31], v[48:51], v[168:171], v[16:31]
    s_add_u32 s47, s48, 28672
    buffer_load_dwordx4 v[164:167], v2, s[4:7], s47 offen sc1
    s_waitcnt vmcnt(8) lgkmcnt(4)
    v_mfma_f32_32x32x16_bf16 v[32:47], v[60:63], v[172:175], v[32:47]
    ds_read_b64_tr_b16 v[48:49], v11 offset:49152
    ds_read_b64_tr_b16 v[50:51], v11 offset:50176
    ds_read_b64_tr_b16 v[52:53], v12 offset:49152
    ds_read_b64_tr_b16 v[54:55], v12 offset:50176
    v_mfma_f32_32x32x16_bf16 v[16:31], v[56:59], v[172:175], v[16:31]
    s_add_u32 s47, s48, 34816
    buffer_load_dwordx4 v[168:171], v2, s[4:7], s47 offen sc1
    s_waitcnt vmcnt(8) lgkmcnt(4)
    v_mfma_f32_32x32x16_bf16 v[32:47], v[248:251], v[176:179], v[32:47]
    ds_read_b64_tr_b16 v[56:57], v11 offset:53248
    ds_read_b64_tr_b16 v[58:59], v11 offset:54272
    ds_read_b64_tr_b16 v[60:61], v12 offset:53248
    ds_read_b64_tr_b16 v[62:63], v12 offset:54272
    v_mfma_f32_32x32x16_bf16 v[16:31], v[244:247], v[176:179], v[16:31]
    s_add_u32 s47, s48, 40960
    buffer_load_dwordx4 v[172:175], v2, s[4:7], s47 offen sc1
    s_waitcnt vmcnt(8) lgkmcnt(4)
    v_mfma_f32_32x32x16_bf16 v[32:47], v[52:55], v[180:183], v[32:47]
    ds_read_b64_tr_b16 v[244:245], v11 offset:57344
    ds_read_b64_tr_b16 v[246:247], v11 offset:58368
    ds_read_b64_tr_b16 v[248:249], v12 offset:57344
    ds_read_b64_tr_b16 v[250:251], v12 offset:58368
    v_mfma_f32_32x32x16_bf16 v[16:31], v[48:51], v[180:183], v[16:31]
    s_add_u32 s47, s48, 47104
    buffer_load_dwordx4 v[176:179], v2, s[4:7], s47 offen sc1
    s_waitcnt vmcnt(8) lgkmcnt(4)
    v_mfma_f32_32x32x16_bf16 v[32:47], v[60:63], v[184:187], v[32:47]
    ds_read_b64_tr_b16 v[48:49], v11 offset:61440
    ds_read_b64_tr_b16 v[50:51], v11 offset:62464
    ds_read_b64_tr_b16 v[52:53], v12 offset:61440
    ds_read_b64_tr_b16 v[54:55], v12 offset:62464
    v_mfma_f32_32x32x16_bf16 v[16:31], v[56:59], v[184:187], v[16:31]
    s_add_u32 s47, s48, 53248
    buffer_load_dwordx4 v[180:183], v2, s[4:7], s47 offen sc1
    s_waitcnt vmcnt(8) lgkmcnt(4)
    v_mfma_f32_32x32x16_bf16 v[32:47], v[248:251], v[188:191], v[32:47]
    ds_read_b64_tr_b16 v[56:57], v13 offset:0
    ds_read_b64_tr_b16 v[58:59], v13 offset:1024
    ds_read_b64_tr_b16 v[60:61], v14 offset:0
    ds_read_b64_tr_b16 v[62:63], v14 offset:1024
    v_mfma_f32_32x32x16_bf16 v[16:31], v[244:247], v[188:191], v[16:31]
    s_add_u32 s47, s48, 59392
    buffer_load_dwordx4 v[184:187], v2, s[4:7], s47 offen sc1
    s_waitcnt vmcnt(8) lgkmcnt(4)
    v_mfma_f32_32x32x16_bf16 v[32:47], v[52:55], v[152:155], v[32:47]
    ds_read_b64_tr_b16 v[244:245], v13 offset:4096
    ds_read_b64_tr_b16 v[246:247], v13 offset:5120
    ds_read_b64_tr_b16 v[248:249], v14 offset:4096
    ds_read_b64_tr_b16 v[250:251], v14 offset:5120
    v_mfma_f32_32x32x16_bf16 v[16:31], v[48:51], v[152:155], v[16:31]
    s_add_u32 s47, s48, 65536
    buffer_load_dwordx4 v[188:191], v2, s[4:7], s47 offen sc1
    s_waitcnt vmcnt(8) lgkmcnt(4)
    v_mfma_f32_32x32x16_bf16 v[32:47], v[60:63], v[156:159], v[32:47]
    ds_read_b64_tr_b16 v[48:49], v13 offset:8192
    ds_read_b64_tr_b16 v[50:51], v13 offset:9216
    ds_read_b64_tr_b16 v[52:53], v14 offset:8192
    ds_read_b64_tr_b16 v[54:55], v14 offset:9216
    v_mfma_f32_32x32x16_bf16 v[16:31], v[56:59], v[156:159], v[16:31]
    s_add_u32 s47, s48, 71680
    buffer_load_dwordx4 v[152:155], v2, s[4:7], s47 offen sc1
    s_waitcnt vmcnt(8) lgkmcnt(4)
    v_mfma_f32_32x32x16_bf16 v[32:47], v[248:251], v[160:163], v[32:47]
    ds_read_b64_tr_b16 v[56:57], v13 offset:12288
    ds_read_b64_tr_b16 v[58:59], v13 offset:13312
    ds_read_b64_tr_b16 v[60:61], v14 offset:12288
    ds_read_b64_tr_b16 v[62:63], v14 offset:13312
    v_mfma_f32_32x32x16_bf16 v[16:31], v[244:247], v[160:163], v[16:31]
    s_add_u32 s47, s48, 77824
    buffer_load_dwordx4 v[156:159], v2, s[4:7], s47 offen sc1
    s_waitcnt vmcnt(8) lgkmcnt(4)
    v_mfma_f32_32x32x16_bf16 v[32:47], v[52:55], v[164:167], v[32:47]
    ds_read_b64_tr_b16 v[244:245], v13 offset:16384
    ds_read_b64_tr_b16 v[246:247], v13 offset:17408
    ds_read_b64_tr_b16 v[248:249], v14 offset:16384
    ds_read_b64_tr_b16 v[250:251], v14 offset:17408
    v_mfma_f32_32x32x16_bf16 v[16:31], v[48:51], v[164:167], v[16:31]
    s_add_u32 s47, s48, 83968
    buffer_load_dwordx4 v[160:163], v2, s[4:7], s47 offen sc1
    s_waitcnt vmcnt(8) lgkmcnt(4)
    v_mfma_f32_32x32x16_bf16 v[32:47], v[60:63], v[168:171], v[32:47]
    ds_read_b64_tr_b16 v[48:49], v13 offset:20480
    ds_read_b64_tr_b16 v[50:51], v13 offset:21504
    ds_read_b64_tr_b16 v[52:53], v14 offset:20480
    ds_read_b64_tr_b16 v[54:55], v14 offset:21504
    v_mfma_f32_32x32x16_bf16 v[16:31], v[56:59], v[168:171], v[16:31]
    s_waitcnt vmcnt(7) lgkmcnt(4)
    v_mfma_f32_32x32x16_bf16 v[32:47], v[248:251], v[172:175], v[32:47]
    ds_read_b64_tr_b16 v[56:57], v13 offset:24576
    ds_read_b64_tr_b16 v[58:59], v13 offset:25600
    ds_read_b64_tr_b16 v[60:61], v14 offset:24576
    ds_read_b64_tr_b16 v[62:63], v14 offset:25600
    v_mfma_f32_32x32x16_bf16 v[16:31], v[244:247], v[172:175], v[16:31]
    s_waitcnt vmcnt(6) lgkmcnt(4)
    v_mfma_f32_32x32x16_bf16 v[32:47], v[52:55], v[176:179], v[32:47]
    ds_read_b64_tr_b16 v[244:245], v13 offset:28672
    ds_read_b64_tr_b16 v[246:247], v13 offset:29696
    ds_read_b64_tr_b16 v[248:249], v14 offset:28672
    ds_read_b64_tr_b16 v[250:251], v14 offset:29696
    v_mfma_f32_32x32x16_bf16 v[16:31], v[48:51], v[176:179], v[16:31]
    s_waitcnt vmcnt(5) lgkmcnt(4)
    v_mfma_f32_32x32x16_bf16 v[32:47], v[60:63], v[180:183], v[32:47]
    ds_read_b64_tr_b16 v[48:49], v4 offset:0
    ds_read_b64_tr_b16 v[50:51], v4 offset:1024
    ds_read_b64_tr_b16 v[52:53], v5 offset:0
    ds_read_b64_tr_b16 v[54:55], v5 offset:1024
    v_mfma_f32_32x32x16_bf16 v[16:31], v[56:59], v[180:183], v[16:31]
    s_waitcnt vmcnt(4) lgkmcnt(4)
    v_mfma_f32_32x32x16_bf16 v[32:47], v[248:251], v[184:187], v[32:47]
    ds_read_b64_tr_b16 v[56:57], v4 offset:4096
    ds_read_b64_tr_b16 v[58:59], v4 offset:5120
    ds_read_b64_tr_b16 v[60:61], v5 offset:4096
    ds_read_b64_tr_b16 v[62:63], v5 offset:5120
    v_mfma_f32_32x32x16_bf16 v[16:31], v[244:247], v[184:187], v[16:31]
    s_waitcnt vmcnt(3) lgkmcnt(4)
    v_mfma_f32_32x32x16_bf16 v[32:47], v[52:55], v[188:191], v[32:47]
    ds_read_b64_tr_b16 v[244:245], v4 offset:8192
    ds_read_b64_tr_b16 v[246:247], v4 offset:9216
    ds_read_b64_tr_b16 v[248:249], v5 offset:8192
    ds_read_b64_tr_b16 v[250:251], v5 offset:9216
    v_mfma_f32_32x32x16_bf16 v[16:31], v[48:51], v[188:191], v[16:31]
    s_waitcnt vmcnt(2) lgkmcnt(4)
    v_mfma_f32_32x32x16_bf16 v[32:47], v[60:63], v[152:155], v[32:47]
    ds_read_b64_tr_b16 v[48:49], v4 offset:12288
    ds_read_b64_tr_b16 v[50:51], v4 offset:13312
    ds_read_b64_tr_b16 v[52:53], v5 offset:12288
    ds_read_b64_tr_b16 v[54:55], v5 offset:13312
    v_mfma_f32_32x32x16_bf16 v[16:31], v[56:59], v[152:155], v[16:31]
    s_waitcnt vmcnt(1) lgkmcnt(4)
    v_mfma_f32_32x32x16_bf16 v[32:47], v[248:251], v[156:159], v[32:47]
    v_mfma_f32_32x32x16_bf16 v[16:31], v[244:247], v[156:159], v[16:31]
    s_waitcnt vmcnt(0) lgkmcnt(0)
    v_mfma_f32_32x32x16_bf16 v[32:47], v[52:55], v[160:163], v[32:47]
    v_mfma_f32_32x32x16_bf16 v[16:31], v[48:51], v[160:163], v[16:31]
    s_nop 10
    ds_write_b128 v204, v[32:35]
    ds_write_b128 v205, v[36:39]
    ds_write_b128 v206, v[40:43]
    ds_write_b128 v207, v[44:47]
    ds_write_b128 v200, v[16:19]
    ds_write_b128 v201, v[20:23]
    ds_write_b128 v202, v[24:27]
    ds_write_b128 v203, v[28:31]
    s_waitcnt lgkmcnt(0)
    s_barrier
    ds_read_b128 v[152:155], v208 offset:0
    ds_read_b128 v[160:163], v208 offset:16384
    ds_read_b128 v[156:159], v209 offset:0
    ds_read_b128 v[164:167], v209 offset:16384
    ds_read_b128 v[168:171], v208 offset:2048
    ds_read_b128 v[176:179], v208 offset:18432
    ds_read_b128 v[172:175], v209 offset:2048
    ds_read_b128 v[180:183], v209 offset:18432
    s_waitcnt lgkmcnt(6)
    v_pk_add_f32 v[152:153], v[152:153], v[160:161]
    v_pk_add_f32 v[154:155], v[154:155], v[162:163]
    v_cvt_pk_bf16_f32 v16, v152, v153
    v_cvt_pk_bf16_f32 v17, v154, v155
    s_waitcnt lgkmcnt(4)
    v_pk_add_f32 v[156:157], v[156:157], v[164:165]
    v_pk_add_f32 v[158:159], v[158:159], v[166:167]
    v_cvt_pk_bf16_f32 v18, v156, v157
    v_cvt_pk_bf16_f32 v19, v158, v159
    buffer_store_dwordx4 v[16:19], v210, s[32:35], 0 offen
    s_waitcnt lgkmcnt(2)
    v_pk_add_f32 v[168:169], v[168:169], v[176:177]
    v_pk_add_f32 v[170:171], v[170:171], v[178:179]
    v_cvt_pk_bf16_f32 v20, v168, v169
    v_cvt_pk_bf16_f32 v21, v170, v171
    s_waitcnt lgkmcnt(0)
    v_pk_add_f32 v[172:173], v[172:173], v[180:181]
    v_pk_add_f32 v[174:175], v[174:175], v[182:183]
    v_cvt_pk_bf16_f32 v22, v172, v173
    v_cvt_pk_bf16_f32 v23, v174, v175
    buffer_store_dwordx4 v[20:23], v211, s[32:35], 0 offen
    s_endpgm
.Ld:
    s_sub_u32 s57, s40, 4
    v_lshrrev_b32 v7, 2, v1
    v_add_u32 v7, 0, v7
    v_mul_u32_u24 v120, 171, v7
    v_lshrrev_b32 v120, 9, v120
    v_mul_u32_u24 v123, 3, v120
    v_sub_u32 v7, v7, v123
    v_mul_u32_u24 v120, 2752, v120
    v_lshl_add_u32 v120, v7, 6, v120
    v_and_b32 v7, 3, v1
    v_lshl_add_u32 v120, v7, 4, v120
    v_lshrrev_b32 v7, 2, v1
    v_add_u32 v7, 16, v7
    v_mul_u32_u24 v121, 171, v7
    v_lshrrev_b32 v121, 9, v121
    v_mul_u32_u24 v123, 3, v121
    v_sub_u32 v7, v7, v123
    v_mul_u32_u24 v121, 2752, v121
    v_lshl_add_u32 v121, v7, 6, v121
    v_and_b32 v7, 3, v1
    v_lshl_add_u32 v121, v7, 4, v121
    v_lshrrev_b32 v7, 2, v1
    v_add_u32 v7, 32, v7
    v_mul_u32_u24 v122, 171, v7
    v_lshrrev_b32 v122, 9, v122
    v_mul_u32_u24 v123, 3, v122
    v_sub_u32 v7, v7, v123
    v_mul_u32_u24 v122, 2752, v122
    v_lshl_add_u32 v122, v7, 6, v122
    v_and_b32 v7, 3, v1
    v_lshl_add_u32 v122, v7, 4, v122
    v_bfe_u32 v4, v1, 2, 2
    v_lshrrev_b32 v7, 5, v1
    v_lshl_add_u32 v4, v7, 2, v4
    v_mul_u32_u24 v4, 192, v4
    v_bfe_u32 v7, v1, 4, 1
    v_lshl_add_u32 v4, v7, 5, v4
    v_and_b32 v7, 3, v1
    v_lshl_add_u32 v4, v7, 3, v4
    v_add_u32 v5, 114688, v4
    s_mul_i32 s50, s57, 3072
    v_add_u32 v8, s50, v4
    v_add_u32 v11, s50, v5
    v_and_b32 v10, 31, v1
    v_lshlrev_b32 v10, 4, v10
    v_add_u32 v10, 94208, v10
    s_lshl_b32 s46, s57, 2
    v_add_u32 v9, s46, v10
    v_mov_b32 v7, 0x3f803f80
    s_mov_b32 s46, 0x10100101
    s_mov_b32 s47, 0x10100101
    v_cndmask_b32 v96, 0, v7, s[46:47]
    v_cndmask_b32 v97, 0, v7, s[46:47]
    v_cndmask_b32 v98, 0, v7, s[46:47]
    v_cndmask_b32 v99, 0, v7, s[46:47]
    s_mov_b32 s46, -1
    s_mov_b32 s47, 0
    v_mov_b32 v7, 0xbb000000
    v_cndmask_b32 v119, 0, v7, s[46:47]
    s_and_b32 s39, s40, 3
    s_lshl_b32 s38, s39, 13
    s_lshl_b32 s39, s39, 10
    s_and_b32 s46, s44, 7
    s_lshl_b32 s46, s46, 7
    s_add_u32 s38, s38, s46
    s_mul_i32 s48, s44, 192
    s_add_u32 s46, s57, 16
    s_mul_i32 s46, s46, 44032
    s_add_u32 s48, s48, s46
    s_lshl_b32 s56, s43, 2
    s_add_u32 s56, s56, s57
    s_waitcnt vmcnt(0)
    v_mov_b32 v6, 0
    v_mov_b32 v7, 1
    s_mov_b64 exec, 1
    s_cmp_eq_u32 s41, 0
    s_cbranch_scc1 .Lms_8_s
    buffer_store_dword v7, v6, s[4:7], s51 offen
.Lms_8_b:
    s_mov_b64 exec, -1
    s_barrier
    s_cmp_ge_u32 s57, 2
    s_cbranch_scc1 .Ld_k16
    s_add_u32 s47, s48, 176128
    s_add_u32 m0, s50, 12288
    s_nop 0
    buffer_load_dwordx4 v120, s[24:27], s47 offen lds
    s_add_u32 m0, s50, 13312
    s_nop 0
    buffer_load_dwordx4 v121, s[24:27], s47 offen lds
    s_add_u32 m0, s50, 14336
    s_nop 0
    buffer_load_dwordx4 v122, s[24:27], s47 offen lds
.Ld_k16:
    s_add_u32 m0, s50, 0
    s_nop 0
    buffer_load_dwordx4 v120, s[24:27], s48 offen lds
    s_add_u32 m0, s50, 1024
    s_nop 0
    buffer_load_dwordx4 v121, s[24:27], s48 offen lds
    s_add_u32 m0, s50, 2048
    s_nop 0
    buffer_load_dwordx4 v122, s[24:27], s48 offen lds
    ds_read_b64_tr_b16 v[12:13], v11 offset:0
    ds_read_b64_tr_b16 v[14:15], v11 offset:1536
    ds_read_b64_tr_b16 v[16:17], v11 offset:64
    ds_read_b64_tr_b16 v[18:19], v11 offset:1600
    ds_read_b64_tr_b16 v[20:21], v11 offset:128
    ds_read_b64_tr_b16 v[22:23], v11 offset:1664
    ds_read_b64_tr_b16 v[24:25], v11 offset:12288
    ds_read_b64_tr_b16 v[26:27], v11 offset:13824
    ds_read_b64_tr_b16 v[28:29], v11 offset:12352
    ds_read_b64_tr_b16 v[30:31], v11 offset:13888
    ds_read_b64_tr_b16 v[32:33], v11 offset:12416
    ds_read_b64_tr_b16 v[34:35], v11 offset:13952
    s_waitcnt lgkmcnt(10)
    v_mfma_f32_16x16x32_bf16 v[84:87], v[96:99], v[12:15], 0
    s_waitcnt lgkmcnt(8)
    v_mfma_f32_16x16x32_bf16 v[88:91], v[96:99], v[16:19], 0
    s_waitcnt lgkmcnt(6)
    v_mfma_f32_16x16x32_bf16 v[92:95], v[96:99], v[20:23], 0
    ds_read_b64_tr_b16 v[12:13], v11 offset:24576
    ds_read_b64_tr_b16 v[14:15], v11 offset:26112
    ds_read_b64_tr_b16 v[16:17], v11 offset:24640
    ds_read_b64_tr_b16 v[18:19], v11 offset:26176
    ds_read_b64_tr_b16 v[20:21], v11 offset:24704
    ds_read_b64_tr_b16 v[22:23], v11 offset:26240
    s_waitcnt lgkmcnt(10)
    v_mfma_f32_16x16x32_bf16 v[84:87], v[96:99], v[24:27], v[84:87]
    s_waitcnt lgkmcnt(8)
    v_mfma_f32_16x16x32_bf16 v[88:91], v[96:99], v[28:31], v[88:91]
    s_waitcnt lgkmcnt(6)
    v_mfma_f32_16x16x32_bf16 v[92:95], v[96:99], v[32:35], v[92:95]
    ds_read_b64_tr_b16 v[24:25], v11 offset:36864
    ds_read_b64_tr_b16 v[26:27], v11 offset:38400
    ds_read_b64_tr_b16 v[28:29], v11 offset:36928
    ds_read_b64_tr_b16 v[30:31], v11 offset:38464
    ds_read_b64_tr_b16 v[32:33], v11 offset:36992
    ds_read_b64_tr_b16 v[34:35], v11 offset:38528
    s_waitcnt lgkmcnt(10)
    v_mfma_f32_16x16x32_bf16 v[84:87], v[96:99], v[12:15], v[84:87]
    s_waitcnt lgkmcnt(8)
    v_mfma_f32_16x16x32_bf16 v[88:91], v[96:99], v[16:19], v[88:91]
    s_waitcnt lgkmcnt(6)
    v_mfma_f32_16x16x32_bf16 v[92:95], v[96:99], v[20:23], v[92:95]
    ds_read_b64_tr_b16 v[12:13], v8 offset:24576
    ds_read_b64_tr_b16 v[14:15], v8 offset:26112
    ds_read_b64_tr_b16 v[16:17], v8 offset:24640
    ds_read_b64_tr_b16 v[18:19], v8 offset:26176
    ds_read_b64_tr_b16 v[20:21], v8 offset:24704
    ds_read_b64_tr_b16 v[22:23], v8 offset:26240
    s_waitcnt lgkmcnt(10)
    v_mfma_f32_16x16x32_bf16 v[84:87], v[96:99], v[24:27], v[84:87]
    s_waitcnt lgkmcnt(8)
    v_mfma_f32_16x16x32_bf16 v[88:91], v[96:99], v[28:31], v[88:91]
    s_waitcnt lgkmcnt(6)
    v_mfma_f32_16x16x32_bf16 v[92:95], v[96:99], v[32:35], v[92:95]
    ds_read_b64_tr_b16 v[24:25], v8 offset:36864
    ds_read_b64_tr_b16 v[26:27], v8 offset:38400
    ds_read_b64_tr_b16 v[28:29], v8 offset:36928
    ds_read_b64_tr_b16 v[30:31], v8 offset:38464
    ds_read_b64_tr_b16 v[32:33], v8 offset:36992
    ds_read_b64_tr_b16 v[34:35], v8 offset:38528
    s_waitcnt lgkmcnt(10)
    v_mfma_f32_16x16x32_bf16 v[84:87], v[96:99], v[12:15], v[84:87]
    s_waitcnt lgkmcnt(8)
    v_mfma_f32_16x16x32_bf16 v[88:91], v[96:99], v[16:19], v[88:91]
    s_waitcnt lgkmcnt(6)
    v_mfma_f32_16x16x32_bf16 v[92:95], v[96:99], v[20:23], v[92:95]
    s_waitcnt vmcnt(0)
    ds_read_b64_tr_b16 v[12:13], v8 offset:12288
    ds_read_b64_tr_b16 v[14:15], v8 offset:13824
    ds_read_b64_tr_b16 v[16:17], v8 offset:12352
    ds_read_b64_tr_b16 v[18:19], v8 offset:13888
    ds_read_b64_tr_b16 v[20:21], v8 offset:12416
    ds_read_b64_tr_b16 v[22:23], v8 offset:13952
    s_waitcnt lgkmcnt(10)
    v_mfma_f32_16x16x32_bf16 v[84:87], v[96:99], v[24:27], v[84:87]
    s_waitcnt lgkmcnt(8)
    v_mfma_f32_16x16x32_bf16 v[88:91], v[96:99], v[28:31], v[88:91]
    s_waitcnt lgkmcnt(6)
    v_mfma_f32_16x16x32_bf16 v[92:95], v[96:99], v[32:35], v[92:95]
    ds_read_b64_tr_b16 v[24:25], v8 offset:0
    ds_read_b64_tr_b16 v[26:27], v8 offset:1536
    ds_read_b64_tr_b16 v[28:29], v8 offset:64
    ds_read_b64_tr_b16 v[30:31], v8 offset:1600
    ds_read_b64_tr_b16 v[32:33], v8 offset:128
    ds_read_b64_tr_b16 v[34:35], v8 offset:1664
    s_waitcnt lgkmcnt(10)
    v_mfma_f32_16x16x32_bf16 v[84:87], v[96:99], v[12:15], v[84:87]
    s_waitcnt lgkmcnt(8)
    v_mfma_f32_16x16x32_bf16 v[88:91], v[96:99], v[16:19], v[88:91]
    s_waitcnt lgkmcnt(6)
    v_mfma_f32_16x16x32_bf16 v[92:95], v[96:99], v[20:23], v[92:95]
    s_waitcnt lgkmcnt(4)
    v_mfma_f32_16x16x32_bf16 v[84:87], v[96:99], v[24:27], v[84:87]
    s_waitcnt lgkmcnt(2)
    v_mfma_f32_16x16x32_bf16 v[88:91], v[96:99], v[28:31], v[88:91]
    s_waitcnt lgkmcnt(0)
    v_mfma_f32_16x16x32_bf16 v[92:95], v[96:99], v[32:35], v[92:95]
    v_and_b32 v6, 15, v1
    v_lshlrev_b32 v6, 2, v6
    s_lshl_b32 s52, s56, 7
    s_add_u32 s52, s52, 15769600
    s_lshl_b32 s48, s56, 15
    s_add_u32 s48, s48, 6291456
    s_lshl_b32 s49, s56, 12
    s_add_u32 s49, s49, 14680064
    s_mul_i32 s50, s56, 88064
    s_mul_i32 s47, s44, 6144
    s_add_u32 s50, s50, s47
    s_add_u32 s50, s50, 8388608
    s_add_u32 s53, s50, 4096
    s_lshl_b32 s51, s56, 7
    s_lshl_b32 s47, s44, 2
    s_add_u32 s51, s51, s47
    s_add_u32 s51, s51, 15777792
    ds_write_b32 v9, v84 offset:0
    ds_write_b32 v9, v88 offset:512
    ds_write_b32 v9, v92 offset:1024
    v_lshlrev_b32 v9, 2, v1
    s_waitcnt lgkmcnt(0)
    s_barrier
    s_add_u32 m0, s39, 49152
    s_add_u32 s47, s38, 0
    buffer_load_dwordx4 v3, s[28:31], s47 offen lds
    s_add_u32 m0, s39, 53248
    s_add_u32 s47, s38, 98304
    buffer_load_dwordx4 v3, s[28:31], s47 offen lds
    s_add_u32 m0, s39, 57344
    s_add_u32 s47, s38, 196608
    buffer_load_dwordx4 v3, s[28:31], s47 offen lds
    s_add_u32 m0, s39, 61440
    s_add_u32 s47, s38, 294912
    buffer_load_dwordx4 v3, s[28:31], s47 offen lds
    s_add_u32 m0, s39, 65536
    s_add_u32 s47, s38, 393216
    buffer_load_dwordx4 v3, s[28:31], s47 offen lds
    s_add_u32 m0, s39, 69632
    s_add_u32 s47, s38, 491520
    buffer_load_dwordx4 v3, s[28:31], s47 offen lds
    s_add_u32 m0, s39, 73728
    s_add_u32 s47, s38, 589824
    buffer_load_dwordx4 v3, s[28:31], s47 offen lds
    s_barrier
    s_add_u32 m0, s39, 77824
    s_add_u32 s47, s38, 688128
    buffer_load_dwordx4 v3, s[28:31], s47 offen lds
    s_add_u32 m0, s39, 81920
    s_add_u32 s47, s38, 786432
    buffer_load_dwordx4 v3, s[28:31], s47 offen lds
    s_add_u32 m0, s39, 86016
    s_add_u32 s47, s38, 884736
    buffer_load_dwordx4 v3, s[28:31], s47 offen lds
    s_add_u32 m0, s39, 90112
    s_add_u32 s47, s38, 983040
    buffer_load_dwordx4 v3, s[28:31], s47 offen lds
    ds_read_b128 v[100:103], v10 offset:0
    ds_read_b128 v[104:107], v10 offset:512
    ds_read_b128 v[108:111], v10 offset:1024
    s_waitcnt vmcnt(0) lgkmcnt(0)
    s_barrier
    s_add_u32 m0, s39, 94208
    s_add_u32 s47, s38, 1081344
    buffer_load_dwordx4 v3, s[28:31], s47 offen lds
    s_add_u32 m0, s39, 98304
    s_add_u32 s47, s38, 1179648
    buffer_load_dwordx4 v3, s[28:31], s47 offen lds
    s_add_u32 m0, s39, 102400
    s_add_u32 s47, s38, 1277952
    buffer_load_dwordx4 v3, s[28:31], s47 offen lds
    s_add_u32 m0, s39, 106496
    s_add_u32 s47, s38, 1376256
    buffer_load_dwordx4 v3, s[28:31], s47 offen lds
    s_add_u32 m0, s39, 110592
    s_add_u32 s47, s38, 32768
    buffer_load_dwordx4 v3, s[28:31], s47 offen lds
    v_mov_b32 v86, 0
    v_mov_b32 v90, 0
    v_mov_b32 v94, 0
    v_mov_b32 v98, 0
    v_mov_b32 v87, 0
    v_mov_b32 v91, 0
    v_mov_b32 v95, 0
    v_mov_b32 v99, 0
    v_add_f32 v100, v100, v101
    v_add_f32 v104, v104, v105
    v_add_f32 v108, v108, v109
    v_add_f32 v102, v102, v103
    v_add_f32 v106, v106, v107
    v_add_f32 v110, v110, v111
    v_add_f32 v100, v100, v102
    v_add_f32 v104, v104, v106
    v_add_f32 v108, v108, v110
    v_cvt_pk_bf16_f32 v101, v100, v100
    v_cvt_pk_bf16_f32 v105, v104, v104
    v_cvt_pk_bf16_f32 v109, v108, v108
    v_and_b32 v101, 0xffff0000, v101
    v_and_b32 v105, 0xffff0000, v105
    v_and_b32 v109, 0xffff0000, v109
    v_sub_f32 v100, v100, v101
    v_sub_f32 v104, v104, v105
    v_sub_f32 v108, v108, v109
    v_cvt_pk_bf16_f32 v84, v101, v100
    v_cvt_pk_bf16_f32 v88, v105, v104
    v_cvt_pk_bf16_f32 v92, v109, v108
    v_mov_b32 v85, v84
    v_mov_b32 v89, v88
    v_mov_b32 v93, v92
    s_barrier
    s_cmp_eq_u32 s44, 15
    s_cbranch_scc1 .Ld_idle
    ds_read_b64_tr_b16 v[12:13], v5 offset:0
    ds_read_b64_tr_b16 v[14:15], v5 offset:1536
    ds_read_b64_tr_b16 v[16:17], v5 offset:64
    ds_read_b64_tr_b16 v[18:19], v5 offset:1600
    ds_read_b64_tr_b16 v[20:21], v5 offset:128
    ds_read_b64_tr_b16 v[22:23], v5 offset:1664
    ds_read_b64_tr_b16 v[24:25], v5 offset:3072
    ds_read_b64_tr_b16 v[26:27], v5 offset:4608
    s_setprio 2
.Lpoll_9:
    buffer_load_dword v7, v6, s[4:7], s52 offen sc1
    s_sub_u32 s45, s45, 1
    s_cbranch_scc0 .Lpoll_9_w
    s_mov_b32 s45, 0
    s_waitcnt vmcnt(0)
    s_branch .Lpoll_9_x
.Lpoll_9_w:
    s_waitcnt vmcnt(0)
    v_cmp_le_u32 vcc, 1, v7
    s_cmp_eq_u64 vcc, -1
    s_cbranch_scc0 .Lpoll_9
.Lpoll_9_x:
    buffer_load_dwordx4 v[128:131], v2, s[4:7], s48 offen offset:0 sc1
    buffer_load_dwordx4 v[132:135], v2, s[4:7], s48 offen offset:1024 sc1
    buffer_load_dwordx4 v[136:139], v2, s[4:7], s48 offen offset:2048 sc1
    buffer_load_dwordx4 v[140:143], v2, s[4:7], s48 offen offset:3072 sc1
    s_add_u32 s52, s48, 4096
    buffer_load_dwordx4 v[144:147], v2, s[4:7], s52 offen offset:0 sc1
    buffer_load_dwordx4 v[148:151], v2, s[4:7], s52 offen offset:1024 sc1
    buffer_load_dwordx4 v[152:155], v2, s[4:7], s52 offen offset:2048 sc1
    buffer_load_dwordx4 v[156:159], v2, s[4:7], s52 offen offset:3072 sc1
    s_waitcnt vmcnt(7)
    s_waitcnt lgkmcnt(6)
    v_mfma_f32_32x32x16_bf16 v[36:51], v[12:15], v[128:131], 0
    ds_read_b64_tr_b16 v[28:29], v5 offset:3136
    ds_read_b64_tr_b16 v[30:31], v5 offset:4672
    s_add_u32 s52, s48, 8192
    buffer_load_dwordx4 v[160:163], v2, s[4:7], s52 offen offset:0 sc1
    s_waitcnt lgkmcnt(6)
    v_mfma_f32_32x32x16_bf16 v[52:67], v[16:19], v[128:131], 0
    ds_read_b64_tr_b16 v[32:33], v5 offset:3200
    ds_read_b64_tr_b16 v[34:35], v5 offset:4736
    buffer_load_dword v100, v9, s[4:7], s49 offen offset:0 sc1
    buffer_load_dword v101, v9, s[4:7], s49 offen offset:256 sc1
    s_waitcnt lgkmcnt(6)
    v_mfma_f32_32x32x16_bf16 v[68:83], v[20:23], v[128:131], 0
    ds_read_b64_tr_b16 v[12:13], v5 offset:6144
    ds_read_b64_tr_b16 v[14:15], v5 offset:7680
    s_waitcnt vmcnt(9)
    s_waitcnt lgkmcnt(6)
    v_mfma_f32_32x32x16_bf16 v[36:51], v[24:27], v[132:135], v[36:51]
    ds_read_b64_tr_b16 v[16:17], v5 offset:6208
    ds_read_b64_tr_b16 v[18:19], v5 offset:7744
    buffer_load_dwordx4 v[164:167], v2, s[4:7], s52 offen offset:1024 sc1
    s_waitcnt lgkmcnt(6)
    v_mfma_f32_32x32x16_bf16 v[52:67], v[28:31], v[132:135], v[52:67]
    ds_read_b64_tr_b16 v[20:21], v5 offset:6272
    ds_read_b64_tr_b16 v[22:23], v5 offset:7808
    buffer_load_dword v102, v9, s[4:7], s49 offen offset:512 sc1
    buffer_load_dword v103, v9, s[4:7], s49 offen offset:768 sc1
    s_waitcnt lgkmcnt(6)
    v_mfma_f32_32x32x16_bf16 v[68:83], v[32:35], v[132:135], v[68:83]
    ds_read_b64_tr_b16 v[24:25], v5 offset:9216
    ds_read_b64_tr_b16 v[26:27], v5 offset:10752
    s_waitcnt vmcnt(11)
    s_waitcnt lgkmcnt(6)
    v_mfma_f32_32x32x16_bf16 v[36:51], v[12:15], v[136:139], v[36:51]
    ds_read_b64_tr_b16 v[28:29], v5 offset:9280
    ds_read_b64_tr_b16 v[30:31], v5 offset:10816
    buffer_load_dwordx4 v[168:171], v2, s[4:7], s52 offen offset:2048 sc1
    s_waitcnt lgkmcnt(6)
    v_mfma_f32_32x32x16_bf16 v[52:67], v[16:19], v[136:139], v[52:67]
    ds_read_b64_tr_b16 v[32:33], v5 offset:9344
    ds_read_b64_tr_b16 v[34:35], v5 offset:10880
    buffer_load_dword v104, v9, s[4:7], s49 offen offset:1024 sc1
    buffer_load_dword v105, v9, s[4:7], s49 offen offset:1280 sc1
    s_waitcnt lgkmcnt(6)
    v_mfma_f32_32x32x16_bf16 v[68:83], v[20:23], v[136:139], v[68:83]
    ds_read_b64_tr_b16 v[12:13], v5 offset:12288
    ds_read_b64_tr_b16 v[14:15], v5 offset:13824
    s_waitcnt vmcnt(13)
    s_waitcnt lgkmcnt(6)
    v_mfma_f32_32x32x16_bf16 v[36:51], v[24:27], v[140:143], v[36:51]
    ds_read_b64_tr_b16 v[16:17], v5 offset:12352
    ds_read_b64_tr_b16 v[18:19], v5 offset:13888
    buffer_load_dwordx4 v[172:175], v2, s[4:7], s52 offen offset:3072 sc1
    s_waitcnt lgkmcnt(6)
    v_mfma_f32_32x32x16_bf16 v[52:67], v[28:31], v[140:143], v[52:67]
    ds_read_b64_tr_b16 v[20:21], v5 offset:12416
    ds_read_b64_tr_b16 v[22:23], v5 offset:13952
    buffer_load_dword v106, v9, s[4:7], s49 offen offset:1536 sc1
    buffer_load_dword v107, v9, s[4:7], s49 offen offset:1792 sc1
    s_waitcnt lgkmcnt(6)
    v_mfma_f32_32x32x16_bf16 v[68:83], v[32:35], v[140:143], v[68:83]
    ds_read_b64_tr_b16 v[24:25], v5 offset:15360
    ds_read_b64_tr_b16 v[26:27], v5 offset:16896
    s_waitcnt vmcnt(15)
    s_waitcnt lgkmcnt(6)
    v_mfma_f32_32x32x16_bf16 v[36:51], v[12:15], v[144:147], v[36:51]
    ds_read_b64_tr_b16 v[28:29], v5 offset:15424
    ds_read_b64_tr_b16 v[30:31], v5 offset:16960
    s_add_u32 s52, s48, 12288
    buffer_load_dwordx4 v[176:179], v2, s[4:7], s52 offen offset:0 sc1
    s_waitcnt lgkmcnt(6)
    v_mfma_f32_32x32x16_bf16 v[52:67], v[16:19], v[144:147], v[52:67]
    ds_read_b64_tr_b16 v[32:33], v5 offset:15488
    ds_read_b64_tr_b16 v[34:35], v5 offset:17024
    buffer_load_dword v108, v9, s[4:7], s49 offen offset:2048 sc1
    buffer_load_dword v109, v9, s[4:7], s49 offen offset:2304 sc1
    s_waitcnt lgkmcnt(6)
    v_mfma_f32_32x32x16_bf16 v[68:83], v[20:23], v[144:147], v[68:83]
    ds_read_b64_tr_b16 v[12:13], v5 offset:18432
    ds_read_b64_tr_b16 v[14:15], v5 offset:19968
    s_waitcnt vmcnt(17)
    s_waitcnt lgkmcnt(6)
    v_mfma_f32_32x32x16_bf16 v[36:51], v[24:27], v[148:151], v[36:51]
    ds_read_b64_tr_b16 v[16:17], v5 offset:18496
    ds_read_b64_tr_b16 v[18:19], v5 offset:20032
    buffer_load_dwordx4 v[180:183], v2, s[4:7], s52 offen offset:1024 sc1
    s_waitcnt lgkmcnt(6)
    v_mfma_f32_32x32x16_bf16 v[52:67], v[28:31], v[148:151], v[52:67]
    ds_read_b64_tr_b16 v[20:21], v5 offset:18560
    ds_read_b64_tr_b16 v[22:23], v5 offset:20096
    buffer_load_dword v110, v9, s[4:7], s49 offen offset:2560 sc1
    buffer_load_dword v111, v9, s[4:7], s49 offen offset:2816 sc1
    s_waitcnt lgkmcnt(6)
    v_mfma_f32_32x32x16_bf16 v[68:83], v[32:35], v[148:151], v[68:83]
    ds_read_b64_tr_b16 v[24:25], v5 offset:21504
    ds_read_b64_tr_b16 v[26:27], v5 offset:23040
    s_waitcnt vmcnt(19)
    s_waitcnt lgkmcnt(6)
    v_mfma_f32_32x32x16_bf16 v[36:51], v[12:15], v[152:155], v[36:51]
    ds_read_b64_tr_b16 v[28:29], v5 offset:21568
    ds_read_b64_tr_b16 v[30:31], v5 offset:23104
    buffer_load_dwordx4 v[184:187], v2, s[4:7], s52 offen offset:2048 sc1
    s_waitcnt lgkmcnt(6)
    v_mfma_f32_32x32x16_bf16 v[52:67], v[16:19], v[152:155], v[52:67]
    ds_read_b64_tr_b16 v[32:33], v5 offset:21632
    ds_read_b64_tr_b16 v[34:35], v5 offset:23168
    buffer_load_dword v112, v9, s[4:7], s49 offen offset:3072 sc1
    buffer_load_dword v113, v9, s[4:7], s49 offen offset:3328 sc1
    s_waitcnt lgkmcnt(6)
    v_mfma_f32_32x32x16_bf16 v[68:83], v[20:23], v[152:155], v[68:83]
    ds_read_b64_tr_b16 v[12:13], v5 offset:24576
    ds_read_b64_tr_b16 v[14:15], v5 offset:26112
    s_waitcnt vmcnt(21)
    s_waitcnt lgkmcnt(6)
    v_mfma_f32_32x32x16_bf16 v[36:51], v[24:27], v[156:159], v[36:51]
    ds_read_b64_tr_b16 v[16:17], v5 offset:24640
    ds_read_b64_tr_b16 v[18:19], v5 offset:26176
    buffer_load_dwordx4 v[188:191], v2, s[4:7], s52 offen offset:3072 sc1
    s_waitcnt lgkmcnt(6)
    v_mfma_f32_32x32x16_bf16 v[52:67], v[28:31], v[156:159], v[52:67]
    ds_read_b64_tr_b16 v[20:21], v5 offset:24704
    ds_read_b64_tr_b16 v[22:23], v5 offset:26240
    buffer_load_dword v114, v9, s[4:7], s49 offen offset:3584 sc1
    buffer_load_dword v115, v9, s[4:7], s49 offen offset:3840 sc1
    s_waitcnt lgkmcnt(6)
    v_mfma_f32_32x32x16_bf16 v[68:83], v[32:35], v[156:159], v[68:83]
    ds_read_b64_tr_b16 v[24:25], v5 offset:27648
    ds_read_b64_tr_b16 v[26:27], v5 offset:29184
    s_waitcnt vmcnt(23)
    s_waitcnt lgkmcnt(6)
    v_mfma_f32_32x32x16_bf16 v[36:51], v[12:15], v[160:163], v[36:51]
    ds_read_b64_tr_b16 v[28:29], v5 offset:27712
    ds_read_b64_tr_b16 v[30:31], v5 offset:29248
    s_add_u32 s52, s48, 16384
    buffer_load_dwordx4 v[192:195], v2, s[4:7], s52 offen offset:0 sc1
    s_waitcnt lgkmcnt(6)
    v_mfma_f32_32x32x16_bf16 v[52:67], v[16:19], v[160:163], v[52:67]
    ds_read_b64_tr_b16 v[32:33], v5 offset:27776
    ds_read_b64_tr_b16 v[34:35], v5 offset:29312
    s_waitcnt lgkmcnt(6)
    v_mfma_f32_32x32x16_bf16 v[68:83], v[20:23], v[160:163], v[68:83]
    ds_read_b64_tr_b16 v[12:13], v5 offset:30720
    ds_read_b64_tr_b16 v[14:15], v5 offset:32256
    s_waitcnt vmcnt(21)
    s_waitcnt lgkmcnt(6)
    v_mfma_f32_32x32x16_bf16 v[36:51], v[24:27], v[164:167], v[36:51]
    ds_read_b64_tr_b16 v[16:17], v5 offset:30784
    ds_read_b64_tr_b16 v[18:19], v5 offset:32320
    buffer_load_dwordx4 v[196:199], v2, s[4:7], s52 offen offset:1024 sc1
    s_waitcnt lgkmcnt(6)
    v_mfma_f32_32x32x16_bf16 v[52:67], v[28:31], v[164:167], v[52:67]
    ds_read_b64_tr_b16 v[20:21], v5 offset:30848
    ds_read_b64_tr_b16 v[22:23], v5 offset:32384
    s_waitcnt lgkmcnt(6)
    v_mfma_f32_32x32x16_bf16 v[68:83], v[32:35], v[164:167], v[68:83]
    ds_read_b64_tr_b16 v[24:25], v5 offset:33792
    ds_read_b64_tr_b16 v[26:27], v5 offset:35328
    s_waitcnt vmcnt(19)
    s_waitcnt lgkmcnt(6)
    v_mfma_f32_32x32x16_bf16 v[36:51], v[12:15], v[168:171], v[36:51]
    ds_read_b64_tr_b16 v[28:29], v5 offset:33856
    ds_read_b64_tr_b16 v[30:31], v5 offset:35392
    buffer_load_dwordx4 v[200:203], v2, s[4:7], s52 offen offset:2048 sc1
    s_waitcnt lgkmcnt(6)
    v_mfma_f32_32x32x16_bf16 v[52:67], v[16:19], v[168:171], v[52:67]
    ds_read_b64_tr_b16 v[32:33], v5 offset:33920
    ds_read_b64_tr_b16 v[34:35], v5 offset:35456
    s_waitcnt lgkmcnt(6)
    v_mfma_f32_32x32x16_bf16 v[68:83], v[20:23], v[168:171], v[68:83]
    ds_read_b64_tr_b16 v[12:13], v5 offset:36864
    ds_read_b64_tr_b16 v[14:15], v5 offset:38400
    s_waitcnt vmcnt(17)
    s_waitcnt lgkmcnt(6)
    v_mfma_f32_32x32x16_bf16 v[36:51], v[24:27], v[172:175], v[36:51]
    ds_read_b64_tr_b16 v[16:17], v5 offset:36928
    ds_read_b64_tr_b16 v[18:19], v5 offset:38464
    buffer_load_dwordx4 v[204:207], v2, s[4:7], s52 offen offset:3072 sc1
    s_waitcnt lgkmcnt(6)
    v_mfma_f32_32x32x16_bf16 v[52:67], v[28:31], v[172:175], v[52:67]
    ds_read_b64_tr_b16 v[20:21], v5 offset:36992
    ds_read_b64_tr_b16 v[22:23], v5 offset:38528
    s_waitcnt lgkmcnt(6)
    v_mfma_f32_32x32x16_bf16 v[68:83], v[32:35], v[172:175], v[68:83]
    ds_read_b64_tr_b16 v[24:25], v5 offset:39936
    ds_read_b64_tr_b16 v[26:27], v5 offset:41472
    s_waitcnt vmcnt(15)
    s_waitcnt lgkmcnt(6)
    v_mfma_f32_32x32x16_bf16 v[36:51], v[12:15], v[176:179], v[36:51]
    ds_read_b64_tr_b16 v[28:29], v5 offset:40000
    ds_read_b64_tr_b16 v[30:31], v5 offset:41536
    s_add_u32 s52, s48, 20480
    buffer_load_dwordx4 v[208:211], v2, s[4:7], s52 offen offset:0 sc1
    s_waitcnt lgkmcnt(6)
    v_mfma_f32_32x32x16_bf16 v[52:67], v[16:19], v[176:179], v[52:67]
    ds_read_b64_tr_b16 v[32:33], v5 offset:40064
    ds_read_b64_tr_b16 v[34:35], v5 offset:41600
    s_waitcnt lgkmcnt(6)
    v_mfma_f32_32x32x16_bf16 v[68:83], v[20:23], v[176:179], v[68:83]
    ds_read_b64_tr_b16 v[12:13], v5 offset:43008
    ds_read_b64_tr_b16 v[14:15], v5 offset:44544
    s_waitcnt vmcnt(13)
    s_waitcnt lgkmcnt(6)
    v_mfma_f32_32x32x16_bf16 v[36:51], v[24:27], v[180:183], v[36:51]
    ds_read_b64_tr_b16 v[16:17], v5 offset:43072
    ds_read_b64_tr_b16 v[18:19], v5 offset:44608
    buffer_load_dwordx4 v[212:215], v2, s[4:7], s52 offen offset:1024 sc1
    s_waitcnt lgkmcnt(6)
    v_mfma_f32_32x32x16_bf16 v[52:67], v[28:31], v[180:183], v[52:67]
    ds_read_b64_tr_b16 v[20:21], v5 offset:43136
    ds_read_b64_tr_b16 v[22:23], v5 offset:44672
    s_waitcnt lgkmcnt(6)
    v_mfma_f32_32x32x16_bf16 v[68:83], v[32:35], v[180:183], v[68:83]
    ds_read_b64_tr_b16 v[24:25], v5 offset:46080
    ds_read_b64_tr_b16 v[26:27], v5 offset:47616
    s_waitcnt vmcnt(11)
    s_waitcnt lgkmcnt(6)
    v_mfma_f32_32x32x16_bf16 v[36:51], v[12:15], v[184:187], v[36:51]
    ds_read_b64_tr_b16 v[28:29], v5 offset:46144
    ds_read_b64_tr_b16 v[30:31], v5 offset:47680
    buffer_load_dwordx4 v[216:219], v2, s[4:7], s52 offen offset:2048 sc1
    s_waitcnt lgkmcnt(6)
    v_mfma_f32_32x32x16_bf16 v[52:67], v[16:19], v[184:187], v[52:67]
    ds_read_b64_tr_b16 v[32:33], v5 offset:46208
    ds_read_b64_tr_b16 v[34:35], v5 offset:47744
    s_waitcnt lgkmcnt(6)
    v_mfma_f32_32x32x16_bf16 v[68:83], v[20:23], v[184:187], v[68:83]
    ds_read_b64_tr_b16 v[12:13], v4 offset:0
    ds_read_b64_tr_b16 v[14:15], v4 offset:1536
    s_waitcnt vmcnt(9)
    s_waitcnt lgkmcnt(6)
    v_mfma_f32_32x32x16_bf16 v[36:51], v[24:27], v[188:191], v[36:51]
    ds_read_b64_tr_b16 v[16:17], v4 offset:64
    ds_read_b64_tr_b16 v[18:19], v4 offset:1600
    buffer_load_dwordx4 v[220:223], v2, s[4:7], s52 offen offset:3072 sc1
    s_waitcnt lgkmcnt(6)
    v_mfma_f32_32x32x16_bf16 v[52:67], v[28:31], v[188:191], v[52:67]
    ds_read_b64_tr_b16 v[20:21], v4 offset:128
    ds_read_b64_tr_b16 v[22:23], v4 offset:1664
    s_waitcnt lgkmcnt(6)
    v_mfma_f32_32x32x16_bf16 v[68:83], v[32:35], v[188:191], v[68:83]
    ds_read_b64_tr_b16 v[24:25], v4 offset:3072
    ds_read_b64_tr_b16 v[26:27], v4 offset:4608
    s_waitcnt vmcnt(7)
    s_waitcnt lgkmcnt(6)
    v_mfma_f32_32x32x16_bf16 v[36:51], v[12:15], v[192:195], v[36:51]
    ds_read_b64_tr_b16 v[28:29], v4 offset:3136
    ds_read_b64_tr_b16 v[30:31], v4 offset:4672
    s_add_u32 s52, s48, 24576
    buffer_load_dwordx4 v[224:227], v2, s[4:7], s52 offen offset:0 sc1
    s_waitcnt lgkmcnt(6)
    v_mfma_f32_32x32x16_bf16 v[52:67], v[16:19], v[192:195], v[52:67]
    ds_read_b64_tr_b16 v[32:33], v4 offset:3200
    ds_read_b64_tr_b16 v[34:35], v4 offset:4736
    s_waitcnt lgkmcnt(6)
    v_mfma_f32_32x32x16_bf16 v[68:83], v[20:23], v[192:195], v[68:83]
    ds_read_b64_tr_b16 v[12:13], v4 offset:6144
    ds_read_b64_tr_b16 v[14:15], v4 offset:7680
    s_waitcnt vmcnt(7)
    s_waitcnt lgkmcnt(6)
    v_mfma_f32_32x32x16_bf16 v[36:51], v[24:27], v[196:199], v[36:51]
    ds_read_b64_tr_b16 v[16:17], v4 offset:6208
    ds_read_b64_tr_b16 v[18:19], v4 offset:7744
    buffer_load_dwordx4 v[228:231], v2, s[4:7], s52 offen offset:1024 sc1
    s_waitcnt lgkmcnt(6)
    v_mfma_f32_32x32x16_bf16 v[52:67], v[28:31], v[196:199], v[52:67]
    ds_read_b64_tr_b16 v[20:21], v4 offset:6272
    ds_read_b64_tr_b16 v[22:23], v4 offset:7808
    s_waitcnt lgkmcnt(6)
    v_mfma_f32_32x32x16_bf16 v[68:83], v[32:35], v[196:199], v[68:83]
    ds_read_b64_tr_b16 v[24:25], v4 offset:9216
    ds_read_b64_tr_b16 v[26:27], v4 offset:10752
    s_waitcnt vmcnt(7)
    s_waitcnt lgkmcnt(6)
    v_mfma_f32_32x32x16_bf16 v[36:51], v[12:15], v[200:203], v[36:51]
    ds_read_b64_tr_b16 v[28:29], v4 offset:9280
    ds_read_b64_tr_b16 v[30:31], v4 offset:10816
    buffer_load_dwordx4 v[232:235], v2, s[4:7], s52 offen offset:2048 sc1
    s_waitcnt lgkmcnt(6)
    v_mfma_f32_32x32x16_bf16 v[52:67], v[16:19], v[200:203], v[52:67]
    ds_read_b64_tr_b16 v[32:33], v4 offset:9344
    ds_read_b64_tr_b16 v[34:35], v4 offset:10880
    s_waitcnt lgkmcnt(6)
    v_mfma_f32_32x32x16_bf16 v[68:83], v[20:23], v[200:203], v[68:83]
    ds_read_b64_tr_b16 v[12:13], v4 offset:12288
    ds_read_b64_tr_b16 v[14:15], v4 offset:13824
    s_waitcnt vmcnt(7)
    s_waitcnt lgkmcnt(6)
    v_mfma_f32_32x32x16_bf16 v[36:51], v[24:27], v[204:207], v[36:51]
    ds_read_b64_tr_b16 v[16:17], v4 offset:12352
    ds_read_b64_tr_b16 v[18:19], v4 offset:13888
    buffer_load_dwordx4 v[236:239], v2, s[4:7], s52 offen offset:3072 sc1
    s_waitcnt lgkmcnt(6)
    v_mfma_f32_32x32x16_bf16 v[52:67], v[28:31], v[204:207], v[52:67]
    ds_read_b64_tr_b16 v[20:21], v4 offset:12416
    ds_read_b64_tr_b16 v[22:23], v4 offset:13952
    s_waitcnt lgkmcnt(6)
    v_mfma_f32_32x32x16_bf16 v[68:83], v[32:35], v[204:207], v[68:83]
    ds_read_b64_tr_b16 v[24:25], v4 offset:15360
    ds_read_b64_tr_b16 v[26:27], v4 offset:16896
    s_waitcnt vmcnt(7)
    s_waitcnt lgkmcnt(6)
    v_mfma_f32_32x32x16_bf16 v[36:51], v[12:15], v[208:211], v[36:51]
    ds_read_b64_tr_b16 v[28:29], v4 offset:15424
    ds_read_b64_tr_b16 v[30:31], v4 offset:16960
    s_add_u32 s52, s48, 28672
    buffer_load_dwordx4 v[240:243], v2, s[4:7], s52 offen offset:0 sc1
    s_waitcnt lgkmcnt(6)
    v_mfma_f32_32x32x16_bf16 v[52:67], v[16:19], v[208:211], v[52:67]
    ds_read_b64_tr_b16 v[32:33], v4 offset:15488
    ds_read_b64_tr_b16 v[34:35], v4 offset:17024
    s_waitcnt lgkmcnt(6)
    v_mfma_f32_32x32x16_bf16 v[68:83], v[20:23], v[208:211], v[68:83]
    ds_read_b64_tr_b16 v[12:13], v4 offset:18432
    ds_read_b64_tr_b16 v[14:15], v4 offset:19968
    buffer_load_dwordx4 v[244:247], v2, s[4:7], s52 offen offset:1024 sc1
    s_waitcnt vmcnt(8)
    s_waitcnt lgkmcnt(6)
    v_mfma_f32_32x32x16_bf16 v[36:51], v[24:27], v[212:215], v[36:51]
    ds_read_b64_tr_b16 v[16:17], v4 offset:18496
    ds_read_b64_tr_b16 v[18:19], v4 offset:20032
    buffer_load_dwordx4 v[248:251], v2, s[4:7], s52 offen offset:2048 sc1
    s_waitcnt lgkmcnt(6)
    v_mfma_f32_32x32x16_bf16 v[52:67], v[28:31], v[212:215], v[52:67]
    ds_read_b64_tr_b16 v[20:21], v4 offset:18560
    ds_read_b64_tr_b16 v[22:23], v4 offset:20096
    s_waitcnt lgkmcnt(6)
    v_mfma_f32_32x32x16_bf16 v[68:83], v[32:35], v[212:215], v[68:83]
    ds_read_b64_tr_b16 v[24:25], v4 offset:21504
    ds_read_b64_tr_b16 v[26:27], v4 offset:23040
    buffer_load_dwordx4 v[252:255], v2, s[4:7], s52 offen offset:3072 sc1
    s_barrier
    s_waitcnt vmcnt(9)
    s_waitcnt lgkmcnt(6)
    v_mfma_f32_32x32x16_bf16 v[36:51], v[12:15], v[216:219], v[36:51]
    ds_read_b64_tr_b16 v[28:29], v4 offset:21568
    ds_read_b64_tr_b16 v[30:31], v4 offset:23104
    s_waitcnt lgkmcnt(6)
    v_mfma_f32_32x32x16_bf16 v[52:67], v[16:19], v[216:219], v[52:67]
    ds_read_b64_tr_b16 v[32:33], v4 offset:21632
    ds_read_b64_tr_b16 v[34:35], v4 offset:23168
    s_waitcnt lgkmcnt(6)
    v_mfma_f32_32x32x16_bf16 v[68:83], v[20:23], v[216:219], v[68:83]
    ds_read_b64_tr_b16 v[12:13], v4 offset:24576
    ds_read_b64_tr_b16 v[14:15], v4 offset:26112
    s_waitcnt vmcnt(8)
    s_waitcnt lgkmcnt(6)
    v_mfma_f32_32x32x16_bf16 v[36:51], v[24:27], v[220:223], v[36:51]
    ds_read_b64_tr_b16 v[16:17], v4 offset:24640
    ds_read_b64_tr_b16 v[18:19], v4 offset:26176
    v_add_f32 v100, v100, v108
    v_add_f32 v101, v101, v109
    v_add_f32 v102, v102, v110
    v_add_f32 v103, v103, v111
    s_waitcnt lgkmcnt(6)
    v_mfma_f32_32x32x16_bf16 v[52:67], v[28:31], v[220:223], v[52:67]
    ds_read_b64_tr_b16 v[20:21], v4 offset:24704
    ds_read_b64_tr_b16 v[22:23], v4 offset:26240
    v_add_f32 v104, v104, v112
    v_add_f32 v105, v105, v113
    v_add_f32 v106, v106, v114
    v_add_f32 v107, v107, v115
    s_waitcnt lgkmcnt(6)
    v_mfma_f32_32x32x16_bf16 v[68:83], v[32:35], v[220:223], v[68:83]
    ds_read_b64_tr_b16 v[24:25], v4 offset:27648
    ds_read_b64_tr_b16 v[26:27], v4 offset:29184
    v_add_f32 v100, v100, v104
    v_add_f32 v101, v101, v105
    v_add_f32 v102, v102, v106
    v_add_f32 v103, v103, v107
    s_waitcnt vmcnt(7)
    s_waitcnt lgkmcnt(6)
    v_mfma_f32_32x32x16_bf16 v[36:51], v[12:15], v[224:227], v[36:51]
    ds_read_b64_tr_b16 v[28:29], v4 offset:27712
    ds_read_b64_tr_b16 v[30:31], v4 offset:29248
    v_add_f32 v100, v100, v102
    v_add_f32 v101, v101, v103
    v_add_f32 v100, v100, v101
    v_mov_b32 v101, v100
    s_waitcnt lgkmcnt(6)
    v_mfma_f32_32x32x16_bf16 v[52:67], v[16:19], v[224:227], v[52:67]
    ds_read_b64_tr_b16 v[32:33], v4 offset:27776
    ds_read_b64_tr_b16 v[34:35], v4 offset:29312
    s_nop 1
    v_permlane32_swap_b32 v100, v101
    s_nop 0
    v_mul_f32 v118, 0xbb000000, v100
    s_waitcnt lgkmcnt(6)
    v_mfma_f32_32x32x16_bf16 v[68:83], v[20:23], v[224:227], v[68:83]
    ds_read_b64_tr_b16 v[12:13], v4 offset:30720
    ds_read_b64_tr_b16 v[14:15], v4 offset:32256
    v_mul_f32 v100, v100, v119
    v_mul_f32 v117, 0x3b000000, v101
    v_cvt_pk_bf16_f32 v96, v100, v100
    v_fma_f32 v117, -v118, v118, v117
    s_waitcnt vmcnt(6)
    s_waitcnt lgkmcnt(6)
    v_mfma_f32_32x32x16_bf16 v[36:51], v[24:27], v[228:231], v[36:51]
    ds_read_b64_tr_b16 v[16:17], v4 offset:30784
    ds_read_b64_tr_b16 v[18:19], v4 offset:32320
    v_lshlrev_b32 v101, 16, v96
    v_max_f32 v117, 0, v117
    v_sub_f32 v100, v100, v101
    v_add_f32 v117, 0x3727c5ac, v117
    s_waitcnt lgkmcnt(6)
    v_mfma_f32_32x32x16_bf16 v[52:67], v[28:31], v[228:231], v[52:67]
    ds_read_b64_tr_b16 v[20:21], v4 offset:30848
    ds_read_b64_tr_b16 v[22:23], v4 offset:32384
    v_cvt_pk_bf16_f32 v97, v100, v100
    v_rsq_f32 v116, v117
    v_sqrt_f32 v117, v117
    s_nop 0
    s_waitcnt lgkmcnt(6)
    v_mfma_f32_32x32x16_bf16 v[68:83], v[32:35], v[228:231], v[68:83]
    ds_read_b64_tr_b16 v[24:25], v4 offset:33792
    ds_read_b64_tr_b16 v[26:27], v4 offset:35328
    v_mul_f32 v116, 0xbfb8aa3b, v116
    s_waitcnt vmcnt(5)
    s_waitcnt lgkmcnt(6)
    v_mfma_f32_32x32x16_bf16 v[36:51], v[12:15], v[232:235], v[36:51]
    ds_read_b64_tr_b16 v[28:29], v4 offset:33856
    ds_read_b64_tr_b16 v[30:31], v4 offset:35392
    s_waitcnt lgkmcnt(6)
    v_mfma_f32_32x32x16_bf16 v[52:67], v[16:19], v[232:235], v[52:67]
    ds_read_b64_tr_b16 v[32:33], v4 offset:33920
    ds_read_b64_tr_b16 v[34:35], v4 offset:35456
    s_waitcnt lgkmcnt(6)
    v_mfma_f32_32x32x16_bf16 v[68:83], v[20:23], v[232:235], v[68:83]
    ds_read_b64_tr_b16 v[12:13], v4 offset:36864
    ds_read_b64_tr_b16 v[14:15], v4 offset:38400
    s_waitcnt vmcnt(4)
    s_waitcnt lgkmcnt(6)
    v_mfma_f32_32x32x16_bf16 v[36:51], v[24:27], v[236:239], v[36:51]
    ds_read_b64_tr_b16 v[16:17], v4 offset:36928
    ds_read_b64_tr_b16 v[18:19], v4 offset:38464
    s_waitcnt lgkmcnt(6)
    v_mfma_f32_32x32x16_bf16 v[52:67], v[28:31], v[236:239], v[52:67]
    ds_read_b64_tr_b16 v[20:21], v4 offset:36992
    ds_read_b64_tr_b16 v[22:23], v4 offset:38528
    s_waitcnt lgkmcnt(6)
    v_mfma_f32_32x32x16_bf16 v[68:83], v[32:35], v[236:239], v[68:83]
    ds_read_b64_tr_b16 v[24:25], v4 offset:39936
    ds_read_b64_tr_b16 v[26:27], v4 offset:41472
    v_mfma_f32_32x32x16_bf16 v[36:51], v[84:87], v[96:99], v[36:51]
    s_waitcnt vmcnt(3)
    s_waitcnt lgkmcnt(6)
    v_mfma_f32_32x32x16_bf16 v[36:51], v[12:15], v[240:243], v[36:51]
    ds_read_b64_tr_b16 v[28:29], v4 offset:40000
    ds_read_b64_tr_b16 v[30:31], v4 offset:41536
    s_waitcnt lgkmcnt(6)
    v_mfma_f32_32x32x16_bf16 v[52:67], v[16:19], v[240:243], v[52:67]
    ds_read_b64_tr_b16 v[32:33], v4 offset:40064
    ds_read_b64_tr_b16 v[34:35], v4 offset:41600
    s_waitcnt lgkmcnt(6)
    v_mfma_f32_32x32x16_bf16 v[68:83], v[20:23], v[240:243], v[68:83]
    ds_read_b64_tr_b16 v[12:13], v4 offset:43008
    ds_read_b64_tr_b16 v[14:15], v4 offset:44544
    v_mfma_f32_32x32x16_bf16 v[52:67], v[88:91], v[96:99], v[52:67]
    s_waitcnt vmcnt(2)
    s_waitcnt lgkmcnt(6)
    v_mfma_f32_32x32x16_bf16 v[36:51], v[24:27], v[244:247], v[36:51]
    ds_read_b64_tr_b16 v[16:17], v4 offset:43072
    ds_read_b64_tr_b16 v[18:19], v4 offset:44608
    s_waitcnt lgkmcnt(6)
    v_mfma_f32_32x32x16_bf16 v[52:67], v[28:31], v[244:247], v[52:67]
    ds_read_b64_tr_b16 v[20:21], v4 offset:43136
    ds_read_b64_tr_b16 v[22:23], v4 offset:44672
    s_waitcnt lgkmcnt(6)
    v_mfma_f32_32x32x16_bf16 v[68:83], v[32:35], v[244:247], v[68:83]
    ds_read_b64_tr_b16 v[24:25], v4 offset:46080
    ds_read_b64_tr_b16 v[26:27], v4 offset:47616
    v_mfma_f32_32x32x16_bf16 v[68:83], v[92:95], v[96:99], v[68:83]
    s_waitcnt vmcnt(1)
    s_waitcnt lgkmcnt(6)
    v_mfma_f32_32x32x16_bf16 v[36:51], v[12:15], v[248:251], v[36:51]
    ds_read_b64_tr_b16 v[28:29], v4 offset:46144
    ds_read_b64_tr_b16 v[30:31], v4 offset:47680
    s_waitcnt lgkmcnt(6)
    v_mfma_f32_32x32x16_bf16 v[52:67], v[16:19], v[248:251], v[52:67]
    ds_read_b64_tr_b16 v[32:33], v4 offset:46208
    ds_read_b64_tr_b16 v[34:35], v4 offset:47744
    s_waitcnt lgkmcnt(6)
    v_mfma_f32_32x32x16_bf16 v[68:83], v[20:23], v[248:251], v[68:83]
    s_waitcnt vmcnt(0)
    s_waitcnt lgkmcnt(4)
    v_mfma_f32_32x32x16_bf16 v[36:51], v[24:27], v[252:255], v[36:51]
    s_waitcnt lgkmcnt(2)
    v_mfma_f32_32x32x16_bf16 v[52:67], v[28:31], v[252:255], v[52:67]
    s_waitcnt lgkmcnt(0)
    v_mfma_f32_32x32x16_bf16 v[68:83], v[32:35], v[252:255], v[68:83]
    s_nop 7
    v_pk_mul_f32 v[100:101], v[36:37], v[116:117] op_sel_hi:[1,0]
    v_pk_mul_f32 v[102:103], v[38:39], v[116:117] op_sel_hi:[1,0]
    v_pk_mul_f32 v[104:105], v[40:41], v[116:117] op_sel_hi:[1,0]
    v_pk_mul_f32 v[106:107], v[42:43], v[116:117] op_sel_hi:[1,0]
    v_exp_f32 v100, v100
    v_exp_f32 v101, v101
    v_exp_f32 v102, v102
    v_exp_f32 v103, v103
    v_exp_f32 v104, v104
    v_exp_f32 v105, v105
    v_exp_f32 v106, v106
    v_exp_f32 v107, v107
    v_pk_fma_f32 v[100:101], v[100:101], v[116:117], v[116:117] op_sel:[0,1,1] op_sel_hi:[1,1,1]
    v_pk_fma_f32 v[102:103], v[102:103], v[116:117], v[116:117] op_sel:[0,1,1] op_sel_hi:[1,1,1]
    v_pk_fma_f32 v[104:105], v[104:105], v[116:117], v[116:117] op_sel:[0,1,1] op_sel_hi:[1,1,1]
    v_pk_fma_f32 v[106:107], v[106:107], v[116:117], v[116:117] op_sel:[0,1,1] op_sel_hi:[1,1,1]
    v_rcp_f32 v100, v100
    v_rcp_f32 v101, v101
    v_rcp_f32 v102, v102
    v_rcp_f32 v103, v103
    v_rcp_f32 v104, v104
    v_rcp_f32 v105, v105
    v_rcp_f32 v106, v106
    v_rcp_f32 v107, v107
    v_pk_mul_f32 v[100:101], v[36:37], v[100:101]
    v_pk_mul_f32 v[102:103], v[38:39], v[102:103]
    v_pk_mul_f32 v[104:105], v[40:41], v[104:105]
    v_pk_mul_f32 v[106:107], v[42:43], v[106:107]
    v_cvt_pk_bf16_f32 v36, v100, v101
    v_cvt_pk_bf16_f32 v37, v102, v103
    v_cvt_pk_bf16_f32 v38, v104, v105
    v_cvt_pk_bf16_f32 v39, v106, v107
    buffer_store_dwordx4 v[36:39], v2, s[4:7], s50 offen offset:0 sc1
    v_pk_mul_f32 v[108:109], v[44:45], v[116:117] op_sel_hi:[1,0]
    v_pk_mul_f32 v[110:111], v[46:47], v[116:117] op_sel_hi:[1,0]
    v_pk_mul_f32 v[112:113], v[48:49], v[116:117] op_sel_hi:[1,0]
    v_pk_mul_f32 v[114:115], v[50:51], v[116:117] op_sel_hi:[1,0]
    v_exp_f32 v108, v108
    v_exp_f32 v109, v109
    v_exp_f32 v110, v110
    v_exp_f32 v111, v111
    v_exp_f32 v112, v112
    v_exp_f32 v113, v113
    v_exp_f32 v114, v114
    v_exp_f32 v115, v115
    v_pk_fma_f32 v[108:109], v[108:109], v[116:117], v[116:117] op_sel:[0,1,1] op_sel_hi:[1,1,1]
    v_pk_fma_f32 v[110:111], v[110:111], v[116:117], v[116:117] op_sel:[0,1,1] op_sel_hi:[1,1,1]
    v_pk_fma_f32 v[112:113], v[112:113], v[116:117], v[116:117] op_sel:[0,1,1] op_sel_hi:[1,1,1]
    v_pk_fma_f32 v[114:115], v[114:115], v[116:117], v[116:117] op_sel:[0,1,1] op_sel_hi:[1,1,1]
    v_rcp_f32 v108, v108
    v_rcp_f32 v109, v109
    v_rcp_f32 v110, v110
    v_rcp_f32 v111, v111
    v_rcp_f32 v112, v112
    v_rcp_f32 v113, v113
    v_rcp_f32 v114, v114
    v_rcp_f32 v115, v115
    v_pk_mul_f32 v[108:109], v[44:45], v[108:109]
    v_pk_mul_f32 v[110:111], v[46:47], v[110:111]
    v_pk_mul_f32 v[112:113], v[48:49], v[112:113]
    v_pk_mul_f32 v[114:115], v[50:51], v[114:115]
    v_cvt_pk_bf16_f32 v44, v108, v109
    v_cvt_pk_bf16_f32 v45, v110, v111
    v_cvt_pk_bf16_f32 v46, v112, v113
    v_cvt_pk_bf16_f32 v47, v114, v115
    buffer_store_dwordx4 v[44:47], v2, s[4:7], s50 offen offset:1024 sc1
    s_cmp_eq_u32 s44, 14
    s_cbranch_scc1 .Ld_short
    v_pk_mul_f32 v[100:101], v[52:53], v[116:117] op_sel_hi:[1,0]
    v_pk_mul_f32 v[102:103], v[54:55], v[116:117] op_sel_hi:[1,0]
    v_pk_mul_f32 v[104:105], v[56:57], v[116:117] op_sel_hi:[1,0]
    v_pk_mul_f32 v[106:107], v[58:59], v[116:117] op_sel_hi:[1,0]
    v_exp_f32 v100, v100
    v_exp_f32 v101, v101
    v_exp_f32 v102, v102
    v_exp_f32 v103, v103
    v_exp_f32 v104, v104
    v_exp_f32 v105, v105
    v_exp_f32 v106, v106
    v_exp_f32 v107, v107
    v_pk_fma_f32 v[100:101], v[100:101], v[116:117], v[116:117] op_sel:[0,1,1] op_sel_hi:[1,1,1]
    v_pk_fma_f32 v[102:103], v[102:103], v[116:117], v[116:117] op_sel:[0,1,1] op_sel_hi:[1,1,1]
    v_pk_fma_f32 v[104:105], v[104:105], v[116:117], v[116:117] op_sel:[0,1,1] op_sel_hi:[1,1,1]
    v_pk_fma_f32 v[106:107], v[106:107], v[116:117], v[116:117] op_sel:[0,1,1] op_sel_hi:[1,1,1]
    v_rcp_f32 v100, v100
    v_rcp_f32 v101, v101
    v_rcp_f32 v102, v102
    v_rcp_f32 v103, v103
    v_rcp_f32 v104, v104
    v_rcp_f32 v105, v105
    v_rcp_f32 v106, v106
    v_rcp_f32 v107, v107
    v_pk_mul_f32 v[100:101], v[52:53], v[100:101]
    v_pk_mul_f32 v[102:103], v[54:55], v[102:103]
    v_pk_mul_f32 v[104:105], v[56:57], v[104:105]
    v_pk_mul_f32 v[106:107], v[58:59], v[106:107]
    v_cvt_pk_bf16_f32 v52, v100, v101
    v_cvt_pk_bf16_f32 v53, v102, v103
    v_cvt_pk_bf16_f32 v54, v104, v105
    v_cvt_pk_bf16_f32 v55, v106, v107
    buffer_store_dwordx4 v[52:55], v2, s[4:7], s50 offen offset:2048 sc1
    v_pk_mul_f32 v[108:109], v[60:61], v[116:117] op_sel_hi:[1,0]
    v_pk_mul_f32 v[110:111], v[62:63], v[116:117] op_sel_hi:[1,0]
    v_pk_mul_f32 v[112:113], v[64:65], v[116:117] op_sel_hi:[1,0]
    v_pk_mul_f32 v[114:115], v[66:67], v[116:117] op_sel_hi:[1,0]
    v_exp_f32 v108, v108
    v_exp_f32 v109, v109
    v_exp_f32 v110, v110
    v_exp_f32 v111, v111
    v_exp_f32 v112, v112
    v_exp_f32 v113, v113
    v_exp_f32 v114, v114
    v_exp_f32 v115, v115
    v_pk_fma_f32 v[108:109], v[108:109], v[116:117], v[116:117] op_sel:[0,1,1] op_sel_hi:[1,1,1]
    v_pk_fma_f32 v[110:111], v[110:111], v[116:117], v[116:117] op_sel:[0,1,1] op_sel_hi:[1,1,1]
    v_pk_fma_f32 v[112:113], v[112:113], v[116:117], v[116:117] op_sel:[0,1,1] op_sel_hi:[1,1,1]
    v_pk_fma_f32 v[114:115], v[114:115], v[116:117], v[116:117] op_sel:[0,1,1] op_sel_hi:[1,1,1]
    v_rcp_f32 v108, v108
    v_rcp_f32 v109, v109
    v_rcp_f32 v110, v110
    v_rcp_f32 v111, v111
    v_rcp_f32 v112, v112
    v_rcp_f32 v113, v113
    v_rcp_f32 v114, v114
    v_rcp_f32 v115, v115
    v_pk_mul_f32 v[108:109], v[60:61], v[108:109]
    v_pk_mul_f32 v[110:111], v[62:63], v[110:111]
    v_pk_mul_f32 v[112:113], v[64:65], v[112:113]
    v_pk_mul_f32 v[114:115], v[66:67], v[114:115]
    v_cvt_pk_bf16_f32 v60, v108, v109
    v_cvt_pk_bf16_f32 v61, v110, v111
    v_cvt_pk_bf16_f32 v62, v112, v113
    v_cvt_pk_bf16_f32 v63, v114, v115
    buffer_store_dwordx4 v[60:63], v2, s[4:7], s50 offen offset:3072 sc1
    v_pk_mul_f32 v[100:101], v[68:69], v[116:117] op_sel_hi:[1,0]
    v_pk_mul_f32 v[102:103], v[70:71], v[116:117] op_sel_hi:[1,0]
    v_pk_mul_f32 v[104:105], v[72:73], v[116:117] op_sel_hi:[1,0]
    v_pk_mul_f32 v[106:107], v[74:75], v[116:117] op_sel_hi:[1,0]
    v_exp_f32 v100, v100
    v_exp_f32 v101, v101
    v_exp_f32 v102, v102
    v_exp_f32 v103, v103
    v_exp_f32 v104, v104
    v_exp_f32 v105, v105
    v_exp_f32 v106, v106
    v_exp_f32 v107, v107
    v_pk_fma_f32 v[100:101], v[100:101], v[116:117], v[116:117] op_sel:[0,1,1] op_sel_hi:[1,1,1]
    v_pk_fma_f32 v[102:103], v[102:103], v[116:117], v[116:117] op_sel:[0,1,1] op_sel_hi:[1,1,1]
    v_pk_fma_f32 v[104:105], v[104:105], v[116:117], v[116:117] op_sel:[0,1,1] op_sel_hi:[1,1,1]
    v_pk_fma_f32 v[106:107], v[106:107], v[116:117], v[116:117] op_sel:[0,1,1] op_sel_hi:[1,1,1]
    v_rcp_f32 v100, v100
    v_rcp_f32 v101, v101
    v_rcp_f32 v102, v102
    v_rcp_f32 v103, v103
    v_rcp_f32 v104, v104
    v_rcp_f32 v105, v105
    v_rcp_f32 v106, v106
    v_rcp_f32 v107, v107
    v_pk_mul_f32 v[100:101], v[68:69], v[100:101]
    v_pk_mul_f32 v[102:103], v[70:71], v[102:103]
    v_pk_mul_f32 v[104:105], v[72:73], v[104:105]
    v_pk_mul_f32 v[106:107], v[74:75], v[106:107]
    v_cvt_pk_bf16_f32 v68, v100, v101
    v_cvt_pk_bf16_f32 v69, v102, v103
    v_cvt_pk_bf16_f32 v70, v104, v105
    v_cvt_pk_bf16_f32 v71, v106, v107
    s_waitcnt vmcnt(2)
    v_mov_b32 v8, 0
    v_mov_b32 v11, 1
    s_mov_b64 exec, 1
    s_cmp_eq_u32 s41, 0
    s_cbranch_scc1 .Lms_10_s
    buffer_store_dword v11, v8, s[4:7], s51 offen
.Lms_10_b:
    s_mov_b64 exec, -1
    buffer_store_dwordx4 v[68:71], v2, s[4:7], s53 offen offset:0 sc1
    v_pk_mul_f32 v[108:109], v[76:77], v[116:117] op_sel_hi:[1,0]
    v_pk_mul_f32 v[110:111], v[78:79], v[116:117] op_sel_hi:[1,0]
    v_pk_mul_f32 v[112:113], v[80:81], v[116:117] op_sel_hi:[1,0]
    v_pk_mul_f32 v[114:115], v[82:83], v[116:117] op_sel_hi:[1,0]
    v_exp_f32 v108, v108
    v_exp_f32 v109, v109
    v_exp_f32 v110, v110
    v_exp_f32 v111, v111
    v_exp_f32 v112, v112
    v_exp_f32 v113, v113
    v_exp_f32 v114, v114
    v_exp_f32 v115, v115
    v_pk_fma_f32 v[108:109], v[108:109], v[116:117], v[116:117] op_sel:[0,1,1] op_sel_hi:[1,1,1]
    v_pk_fma_f32 v[110:111], v[110:111], v[116:117], v[116:117] op_sel:[0,1,1] op_sel_hi:[1,1,1]
    v_pk_fma_f32 v[112:113], v[112:113], v[116:117], v[116:117] op_sel:[0,1,1] op_sel_hi:[1,1,1]
    v_pk_fma_f32 v[114:115], v[114:115], v[116:117], v[116:117] op_sel:[0,1,1] op_sel_hi:[1,1,1]
    v_rcp_f32 v108, v108
    v_rcp_f32 v109, v109
    v_rcp_f32 v110, v110
    v_rcp_f32 v111, v111
    v_rcp_f32 v112, v112
    v_rcp_f32 v113, v113
    v_rcp_f32 v114, v114
    v_rcp_f32 v115, v115
    v_pk_mul_f32 v[108:109], v[76:77], v[108:109]
    v_pk_mul_f32 v[110:111], v[78:79], v[110:111]
    v_pk_mul_f32 v[112:113], v[80:81], v[112:113]
    v_pk_mul_f32 v[114:115], v[82:83], v[114:115]
    v_cvt_pk_bf16_f32 v76, v108, v109
    v_cvt_pk_bf16_f32 v77, v110, v111
    v_cvt_pk_bf16_f32 v78, v112, v113
    v_cvt_pk_bf16_f32 v79, v114, v115
    buffer_store_dwordx4 v[76:79], v2, s[4:7], s53 offen offset:1024 sc1
    s_waitcnt vmcnt(3)
    v_mov_b32 v8, 0
    v_mov_b32 v11, 3
    s_mov_b64 exec, 1
    s_cmp_eq_u32 s41, 0
    s_cbranch_scc1 .Lms_11_s
    buffer_store_dword v11, v8, s[4:7], s51 offen
.Lms_11_b:
    s_mov_b64 exec, -1
    s_waitcnt vmcnt(1)
    v_mov_b32 v8, 0
    v_mov_b32 v11, 7
    s_mov_b64 exec, 1
    s_cmp_eq_u32 s41, 0
    s_cbranch_scc1 .Lms_12_s
    buffer_store_dword v11, v8, s[4:7], s51 offen
.Lms_12_b:
    s_mov_b64 exec, -1
.Ld_tail:
    s_cmp_lg_u32 s40, 4
    s_cbranch_scc1 .Ld_bar
    v_bfe_u32 v7, v1, 4, 1
    v_lshl_add_u32 v6, v7, 7, v6
    s_lshl_b32 s48, s43, 2
    s_lshr_b32 s47, s44, 3
    s_lshl_b32 s47, s47, 1
    s_add_u32 s48, s48, s47
    s_lshl_b32 s48, s48, 7
    s_add_u32 s48, s48, 15777792
.Lpoll_13:
    buffer_load_dword v7, v6, s[4:7], s48 offen sc1
    s_sub_u32 s45, s45, 1
    s_cbranch_scc0 .Lpoll_13_w
    s_mov_b32 s45, 0
    s_waitcnt vmcnt(0)
    s_branch .Lpoll_13_x
.Lpoll_13_w:
    s_waitcnt vmcnt(0)
    v_cmp_le_u32 vcc, 3, v7
    s_cmp_eq_u64 vcc, -1
    s_cbranch_scc0 .Lpoll_13
.Lpoll_13_x:
    s_barrier
.Lpoll_14:
    buffer_load_dword v7, v6, s[4:7], s48 offen sc1
    s_sub_u32 s45, s45, 1
    s_cbranch_scc0 .Lpoll_14_w
    s_mov_b32 s45, 0
    s_waitcnt vmcnt(0)
    s_branch .Lpoll_14_x
.Lpoll_14_w:
    s_waitcnt vmcnt(0)
    v_cmp_le_u32 vcc, 7, v7
    s_cmp_eq_u64 vcc, -1
    s_cbranch_scc0 .Lpoll_14
.Lpoll_14_x:
    s_barrier
.Ld_end:
    s_endpgm
.Ld_bar:
    s_barrier
    s_barrier
    s_branch .Ld_end
.Ld_idle:
    s_waitcnt vmcnt(0)
    s_barrier
.Ld_short:
    s_waitcnt vmcnt(0)
    v_mov_b32 v8, 0
    v_mov_b32 v11, 7
    s_mov_b64 exec, 1
    s_cmp_eq_u32 s41, 0
    s_cbranch_scc1 .Lms_15_s
    buffer_store_dword v11, v8, s[4:7], s51 offen
.Lms_15_b:
    s_mov_b64 exec, -1
    s_branch .Ld_tail
.Lb_late:
.Lpoll_16:
    buffer_load_dword v7, v6, s[4:7], s39 offen sc1
    s_sub_u32 s45, s45, 1
    s_cbranch_scc0 .Lpoll_16_w
    s_mov_b32 s45, 0
    s_waitcnt vmcnt(0)
    s_branch .Lpoll_16_x
.Lpoll_16_w:
    s_waitcnt vmcnt(0)
    v_cmp_le_u32 vcc, 1, v7
    s_cmp_eq_u64 vcc, -1
    s_cbranch_scc0 .Lpoll_16
.Lpoll_16_x:
    v_mov_b32 v90, 1
    s_branch .Lb_seen
.Lb_slow:
    s_lshl_b32 s46, s44, 18
    s_mov_b32 s47, s46
    s_mov_b32 s48, 0
    v_mov_b32 v6, 0xff800000
.Lb_max:
    buffer_load_dwordx4 v[12:15], v4, s[4:7], s47 offen sc1
    s_add_u32 s47, s47, 4096
    s_waitcnt vmcnt(0)
    v_mfma_f32_32x32x16_bf16 v[36:51], v[12:15], v[8:11], 0
    s_nop 11
    v_max3_f32 v6, v6, v36, v37
    v_max3_f32 v6, v6, v38, v39
    v_max3_f32 v6, v6, v40, v41
    v_max3_f32 v6, v6, v42, v43
    v_max3_f32 v6, v6, v44, v45
    v_max3_f32 v6, v6, v46, v47
    v_max3_f32 v6, v6, v48, v49
    v_max3_f32 v6, v6, v50, v51
    s_add_u32 s48, s48, 1
    s_cmp_lt_u32 s48, 64
    s_cbranch_scc1 .Lb_max
    v_mov_b32 v7, v6
    s_nop 1
    v_permlane32_swap_b32 v6, v7
    s_nop 0
    v_max_f32 v6, v6, v7
    v_sub_f32 v96, 0, v6
    v_mov_b32 v68, 0
    v_sub_f32 v97, 0, v6
    v_mov_b32 v69, 0
    v_sub_f32 v98, 0, v6
    v_mov_b32 v70, 0
    v_sub_f32 v99, 0, v6
    v_mov_b32 v71, 0
    v_sub_f32 v100, 0, v6
    v_mov_b32 v72, 0
    v_sub_f32 v101, 0, v6
    v_mov_b32 v73, 0
    v_sub_f32 v102, 0, v6
    v_mov_b32 v74, 0
    v_sub_f32 v103, 0, v6
    v_mov_b32 v75, 0
    v_sub_f32 v104, 0, v6
    v_mov_b32 v76, 0
    v_sub_f32 v105, 0, v6
    v_mov_b32 v77, 0
    v_sub_f32 v106, 0, v6
    v_mov_b32 v78, 0
    v_sub_f32 v107, 0, v6
    v_mov_b32 v79, 0
    v_sub_f32 v108, 0, v6
    v_mov_b32 v80, 0
    v_sub_f32 v109, 0, v6
    v_mov_b32 v81, 0
    v_sub_f32 v110, 0, v6
    v_mov_b32 v82, 0
    v_sub_f32 v111, 0, v6
    v_mov_b32 v83, 0
    s_mov_b32 s48, 0
.Lb_redo:
    buffer_load_dwordx4 v[12:15], v4, s[4:7], s46 offen sc1
    s_mov_b64 exec, s[54:55]
    buffer_load_dwordx4 v[20:23], v5, s[4:7], s46 offen offset:1024 sc1
    buffer_load_dwordx4 v[24:27], v5, s[4:7], s46 offen offset:1536 sc1
    s_mov_b64 exec, -1
    s_add_u32 s46, s46, 4096
    s_waitcnt vmcnt(0)
    v_mfma_f32_32x32x16_bf16 v[36:51], v[12:15], v[8:11], v[96:111]
    s_nop 11
    v_exp_f32 v36, v36
    v_exp_f32 v37, v37
    v_exp_f32 v38, v38
    v_exp_f32 v39, v39
    v_exp_f32 v40, v40
    v_exp_f32 v41, v41
    v_exp_f32 v42, v42
    v_exp_f32 v43, v43
    v_exp_f32 v44, v44
    v_exp_f32 v45, v45
    v_exp_f32 v46, v46
    v_exp_f32 v47, v47
    v_exp_f32 v48, v48
    v_exp_f32 v49, v49
    v_exp_f32 v50, v50
    v_exp_f32 v51, v51
    s_nop 1
    v_smfmac_f32_32x32x32_bf16 v[68:83], v[20:23], v[36:43], v84
    v_smfmac_f32_32x32x32_bf16 v[68:83], v[24:27], v[44:51], v84
    s_nop 7
    s_add_u32 s48, s48, 1
    s_cmp_lt_u32 s48, 64
    s_cbranch_scc1 .Lb_redo
    s_nop 3
    v_rcp_f32 v6, v76
    s_nop 0
    s_branch .Lb_out
.Lms_4_s:
    buffer_store_dword v9, v8, s[4:7], s51 offen sc1
    s_branch .Lms_4_b
.Lms_6_s:
    buffer_store_dword v9, v8, s[4:7], s51 offen sc1
    s_branch .Lms_6_b
.Lms_8_s:
    buffer_store_dword v7, v6, s[4:7], s51 offen sc1
    s_branch .Lms_8_b
.Lms_10_s:
    buffer_store_dword v11, v8, s[4:7], s51 offen sc1
    s_branch .Lms_10_b
.Lms_11_s:
    buffer_store_dword v11, v8, s[4:7], s51 offen sc1
    s_branch .Lms_11_b
.Lms_12_s:
    buffer_store_dword v11, v8, s[4:7], s51 offen sc1
    s_branch .Lms_12_b
.Lms_15_s:
    buffer_store_dword v11, v8, s[4:7], s51 offen sc1
    s_branch .Lms_15_b
.Lend:
    s_endpgm
.Lcode_end:
.section .rodata,"a"
.p2align 6
.amdhsa_kernel sequential_preLN__mha_block__dense_activation_silu__prompt_kernel
.amdhsa_next_free_vgpr 256
.amdhsa_next_free_sgpr 102
.amdhsa_accum_offset 256
.amdhsa_group_segment_fixed_size 0
.amdhsa_kernarg_size 72
.amdhsa_user_sgpr_count 2
.amdhsa_user_sgpr_kernarg_segment_ptr 1
.amdhsa_system_sgpr_workgroup_id_x 1
.amdhsa_float_denorm_mode_32 3
.end_amdhsa_kernel
```
